```python
import torch

def _softmax(x, axis=-1):
    return torch.softmax(x, dim=axis)
def _gelu(x):
    return torch.nn.functional.gelu(x, approximate="tanh")
def _silu(x):
    return torch.nn.functional.silu(x)
def _sigmoid(x):
    return torch.sigmoid(x)
def _layernorm(x, axis=-1, eps=1e-5):
    m = x.mean(dim=axis, keepdim=True)
    v = x.var(dim=axis, keepdim=True, unbiased=False)
    return (x - m) / torch.sqrt(v + eps)
def _scatter_add(tgt, idx, src, axis=0):
    return tgt.clone().index_add_(axis, idx, src)
def _segment_sum(src, seg, n):
    out = torch.zeros((n,) + src.shape[1:], dtype=src.dtype)
    return out.index_add_(0, seg, src)
def _pad(x, pw):
    flat = tuple(v for pair in reversed(pw) for v in pair)
    return torch.nn.functional.pad(x, flat)

kernel_name = 'standalone__mha_block_cached__near_ridge'

def setup_inputs():

    _w = (lambda a: (lambda t: t.to(torch.bfloat16) if t.is_floating_point() else t)(torch.as_tensor(a)))
    B, Sq, D = 16, 32, 1024
    H, Sk, Dh = 32, 32, 128
    return {
        "x": _w((lambda *s: torch.randn(*s, dtype=torch.bfloat16) * 0.8)(B, Sq, D)),
        "k_cache": _w((lambda *s: torch.randn(*s, dtype=torch.bfloat16) * 0.8)(B, H, Sk, Dh)),
        "v_cache": _w((lambda *s: torch.randn(*s, dtype=torch.bfloat16) * 0.05)(B, H, Sk, Dh)),
        "wq": _w((lambda *s: torch.randn(*s, dtype=torch.bfloat16) * 0.8)(D, H * Dh) * (D ** -0.5)),
        "wo": _w((lambda *s: torch.randn(*s, dtype=torch.bfloat16) * 0.05)(H * Dh, D) * ((H * Dh) ** -0.5)),
    }

def reference(x, k_cache, v_cache, wq, wo):
    B, Sq, D = x.shape
    H, Dh = 32, 128
    q = (lambda x, *d: x.permute(*d))((x @ wq).reshape(B, Sq, H, Dh), 0, 2, 1, 3)
    scores = torch.einsum("bhqd,bhkd->bhqk", q, k_cache) * (Dh ** -0.5)
    p = _softmax(scores, axis=-1)
    o = torch.einsum("bhqk,bhkd->bhqd", p, v_cache)
    return (lambda x, *d: x.permute(*d))(o, 0, 2, 1, 3).reshape(B, Sq, H * Dh) @ wo
```

```asm
; @launch kernel=mha_qattn_kernel grid=(256,1,1) block=(256,1,1) lds=131072
; @launch kernel=mha_oproj_kernel grid=(256,1,1) block=(256,1,1) lds=98304
; @launch kernel=mha_reduce_kernel grid=(256,1,1) block=(256,1,1) lds=0
.amdgcn_target "amdgcn-amd-amdhsa--gfx950"
.text
.globl mha_qattn_kernel
.p2align 8
.type mha_qattn_kernel,@function
mha_qattn_kernel:
    s_cmp_ge_u32 s2, 256
    s_cbranch_scc1 L1_done
    s_load_dwordx4 s[44:47], s[0:1], 0
    s_load_dwordx4 s[48:51], s[0:1], 16
    s_load_dwordx2 s[52:53], s[0:1], 56
    s_and_b32 s3, s2, 7
    s_lshl_b32 s3, s3, 2
    s_bfe_u32 s4, s2, 0x20003
    s_add_u32 s3, s3, s4
    s_lshr_b32 s4, s2, 5
    s_waitcnt lgkmcnt(0)
    s_mov_b32 s8, s44
    s_mov_b32 s9, s45
    s_mov_b32 s10, 1048576
    s_mov_b32 s11, 0x00020000
    s_mov_b32 s12, s50
    s_mov_b32 s13, s51
    s_mov_b32 s14, 8388608
    s_mov_b32 s15, 0x00020000
    s_mov_b32 s16, s46
    s_mov_b32 s17, s47
    s_mov_b32 s18, 4194304
    s_mov_b32 s19, 0x00020000
    s_mov_b32 s20, s48
    s_mov_b32 s21, s49
    s_mov_b32 s22, 4194304
    s_mov_b32 s23, 0x00020000
    s_mov_b32 s24, s52
    s_mov_b32 s25, s53
    s_mov_b32 s26, 4194304
    s_mov_b32 s27, 0x00020000
    s_lshl_b32 s30, s4, 17
    s_lshl_b32 s31, s3, 8
    v_and_b32 v1, 63, v0
    v_lshrrev_b32 v2, 6, v0
    s_nop 0
    v_readfirstlane_b32 s28, v2
    s_nop 3
    s_lshl_b32 s32, s28, 11
    s_lshl_b32 s33, s28, 12
    v_lshrrev_b32 v2, 3, v1
    v_lshrrev_b32 v3, 4, v1
    v_and_b32 v4, 7, v1
    v_xor_b32 v4, v4, v3
    s_lshl_b32 s34, s28, 4
    v_add_u32 v2, s34, v2
    s_mov_b32 s35, 2048
    v_mul_lo_u32 v2, v2, s35
    v_lshl_add_u32 v10, v4, 4, v2
    v_add_u32 v10, s30, v10
    v_xor_b32 v11, 64, v10
    v_add_u32 v11, 16384, v11
    v_and_b32 v4, 15, v1
    v_lshlrev_b32 v5, 2, v3
    v_xor_b32 v4, v4, v5
    s_lshl_b32 s34, s28, 4
    v_add_u32 v5, s34, v3
    s_mov_b32 s35, 8192
    v_mul_lo_u32 v5, v5, s35
    v_lshl_add_u32 v12, v4, 4, v5
    v_add_u32 v12, s31, v12
    s_and_b32 s36, s28, 1
    s_lshr_b32 s37, s28, 1
    v_and_b32 v2, 31, v1
    v_lshrrev_b32 v3, 5, v1
    v_lshrrev_b32 v4, 1, v2
    v_and_b32 v4, 7, v4
    v_xor_b32 v4, v4, v3
    s_lshl_b32 s38, s36, 12
    v_lshlrev_b32 v5, 7, v2
    v_add_u32 v5, s38, v5
    v_xor_b32 v6, 0, v4
    v_lshl_add_u32 v16, v6, 4, v5
    v_add_u32 v20, 49152, v16
    v_xor_b32 v6, 2, v4
    v_lshl_add_u32 v17, v6, 4, v5
    v_add_u32 v21, 49152, v17
    v_xor_b32 v6, 4, v4
    v_lshl_add_u32 v18, v6, 4, v5
    v_add_u32 v22, 49152, v18
    v_xor_b32 v6, 6, v4
    v_lshl_add_u32 v19, v6, 4, v5
    v_add_u32 v23, 49152, v19
    v_lshrrev_b32 v2, 4, v1
    v_and_b32 v3, 15, v1
    v_lshrrev_b32 v4, 1, v2
    v_lshlrev_b32 v4, 3, v4
    v_lshrrev_b32 v5, 2, v3
    v_add_u32 v4, v4, v5
    v_and_b32 v6, 1, v2
    v_lshlrev_b32 v6, 1, v6
    v_bfe_u32 v7, v3, 1, 1
    v_add_u32 v6, v6, v7
    s_lshl_b32 s38, s37, 3
    v_add_u32 v6, s38, v6
    v_lshlrev_b32 v5, 2, v5
    v_xor_b32 v6, v6, v5
    v_lshlrev_b32 v6, 4, v6
    v_and_b32 v7, 1, v3
    v_lshl_add_u32 v6, v7, 3, v6
    v_lshl_add_u32 v6, v4, 8, v6
    v_add_u32 v24, 8192, v6
    v_xor_b32 v25, 64, v24
    v_add_u32 v26, 49152, v24
    v_add_u32 v27, 49152, v25
    v_mov_b32 v64, 0
    v_mov_b32 v65, 0
    v_mov_b32 v66, 0
    v_mov_b32 v67, 0
    v_mov_b32 v68, 0
    v_mov_b32 v69, 0
    v_mov_b32 v70, 0
    v_mov_b32 v71, 0
    v_mov_b32 v72, 0
    v_mov_b32 v73, 0
    v_mov_b32 v74, 0
    v_mov_b32 v75, 0
    v_mov_b32 v76, 0
    v_mov_b32 v77, 0
    v_mov_b32 v78, 0
    v_mov_b32 v79, 0
    v_mov_b32 v80, 0
    v_mov_b32 v81, 0
    v_mov_b32 v82, 0
    v_mov_b32 v83, 0
    v_mov_b32 v84, 0
    v_mov_b32 v85, 0
    v_mov_b32 v86, 0
    v_mov_b32 v87, 0
    v_mov_b32 v88, 0
    v_mov_b32 v89, 0
    v_mov_b32 v90, 0
    v_mov_b32 v91, 0
    v_mov_b32 v92, 0
    v_mov_b32 v93, 0
    v_mov_b32 v94, 0
    v_mov_b32 v95, 0
    v_lshrrev_b32 v2, 4, v1
    v_and_b32 v3, 15, v1
    s_lshl_b32 s38, s4, 1
    s_add_u32 s38, s38, s37
    s_lshl_b32 s38, s38, 5
    s_add_u32 s38, s38, s3
    s_lshl_b32 s38, s38, 13
    s_lshl_b32 s39, s28, 13
    s_add_u32 s39, s39, 98304
    s_cmp_eq_u32 s36, 0
    s_cbranch_scc0 L1_vload
    v_add_u32 v4, 0, v2
    v_xor_b32 v4, v3, v4
    v_lshlrev_b32 v4, 4, v4
    v_lshl_add_u32 v4, v2, 8, v4
    s_add_u32 m0, s39, 0
    s_add_u32 s40, s38, 0
    buffer_load_dwordx4 v4, s[16:19], s40 offen lds
    v_add_u32 v4, 4, v2
    v_xor_b32 v4, v3, v4
    v_lshlrev_b32 v4, 4, v4
    v_lshl_add_u32 v4, v2, 8, v4
    s_add_u32 m0, s39, 1024
    s_add_u32 s40, s38, 1024
    buffer_load_dwordx4 v4, s[16:19], s40 offen lds
    v_add_u32 v4, 8, v2
    v_xor_b32 v4, v3, v4
    v_lshlrev_b32 v4, 4, v4
    v_lshl_add_u32 v4, v2, 8, v4
    s_add_u32 m0, s39, 2048
    s_add_u32 s40, s38, 2048
    buffer_load_dwordx4 v4, s[16:19], s40 offen lds
    v_add_u32 v4, 12, v2
    v_xor_b32 v4, v3, v4
    v_lshlrev_b32 v4, 4, v4
    v_lshl_add_u32 v4, v2, 8, v4
    s_add_u32 m0, s39, 3072
    s_add_u32 s40, s38, 3072
    buffer_load_dwordx4 v4, s[16:19], s40 offen lds
    v_add_u32 v4, 0, v2
    v_xor_b32 v4, v3, v4
    v_lshlrev_b32 v4, 4, v4
    v_lshl_add_u32 v4, v2, 8, v4
    s_add_u32 m0, s39, 4096
    s_add_u32 s40, s38, 4096
    buffer_load_dwordx4 v4, s[16:19], s40 offen lds
    v_add_u32 v4, 4, v2
    v_xor_b32 v4, v3, v4
    v_lshlrev_b32 v4, 4, v4
    v_lshl_add_u32 v4, v2, 8, v4
    s_add_u32 m0, s39, 5120
    s_add_u32 s40, s38, 5120
    buffer_load_dwordx4 v4, s[16:19], s40 offen lds
    v_add_u32 v4, 8, v2
    v_xor_b32 v4, v3, v4
    v_lshlrev_b32 v4, 4, v4
    v_lshl_add_u32 v4, v2, 8, v4
    s_add_u32 m0, s39, 6144
    s_add_u32 s40, s38, 6144
    buffer_load_dwordx4 v4, s[16:19], s40 offen lds
    v_add_u32 v4, 12, v2
    v_xor_b32 v4, v3, v4
    v_lshlrev_b32 v4, 4, v4
    v_lshl_add_u32 v4, v2, 8, v4
    s_add_u32 m0, s39, 7168
    s_add_u32 s40, s38, 7168
    buffer_load_dwordx4 v4, s[16:19], s40 offen lds
    s_branch L1_kvdone
L1_vload:
    v_lshlrev_b32 v4, 2, v2
    v_xor_b32 v4, v3, v4
    v_lshlrev_b32 v4, 4, v4
    v_lshl_add_u32 v4, v2, 8, v4
    s_add_u32 m0, s39, 0
    s_add_u32 s40, s38, 0
    buffer_load_dwordx4 v4, s[20:23], s40 offen lds
    s_add_u32 m0, s39, 1024
    s_add_u32 s40, s38, 1024
    buffer_load_dwordx4 v4, s[20:23], s40 offen lds
    s_add_u32 m0, s39, 2048
    s_add_u32 s40, s38, 2048
    buffer_load_dwordx4 v4, s[20:23], s40 offen lds
    s_add_u32 m0, s39, 3072
    s_add_u32 s40, s38, 3072
    buffer_load_dwordx4 v4, s[20:23], s40 offen lds
    s_add_u32 m0, s39, 4096
    s_add_u32 s40, s38, 4096
    buffer_load_dwordx4 v4, s[20:23], s40 offen lds
    s_add_u32 m0, s39, 5120
    s_add_u32 s40, s38, 5120
    buffer_load_dwordx4 v4, s[20:23], s40 offen lds
    s_add_u32 m0, s39, 6144
    s_add_u32 s40, s38, 6144
    buffer_load_dwordx4 v4, s[20:23], s40 offen lds
    s_add_u32 m0, s39, 7168
    s_add_u32 s40, s38, 7168
    buffer_load_dwordx4 v4, s[20:23], s40 offen lds
L1_kvdone:
    s_add_u32 m0, s32, 0
    s_mov_b32 s40, 0
    buffer_load_dwordx4 v10, s[8:11], s40 offen lds
    s_add_u32 m0, s32, 1024
    s_mov_b32 s40, 0
    buffer_load_dwordx4 v11, s[8:11], s40 offen lds
    s_add_u32 m0, s33, 8192
    s_mov_b32 s40, 0
    buffer_load_dwordx4 v12, s[12:15], s40 offen lds
    s_add_u32 m0, s33, 9216
    s_mov_b32 s40, 32768
    buffer_load_dwordx4 v12, s[12:15], s40 offen lds
    s_add_u32 m0, s33, 10240
    s_mov_b32 s40, 65536
    buffer_load_dwordx4 v12, s[12:15], s40 offen lds
    s_add_u32 m0, s33, 11264
    s_mov_b32 s40, 98304
    buffer_load_dwordx4 v12, s[12:15], s40 offen lds
    s_add_u32 m0, s32, 24576
    s_mov_b32 s40, 128
    buffer_load_dwordx4 v10, s[8:11], s40 offen lds
    s_add_u32 m0, s32, 25600
    s_mov_b32 s40, 128
    buffer_load_dwordx4 v11, s[8:11], s40 offen lds
    s_add_u32 m0, s33, 32768
    s_mov_b32 s40, 524288
    buffer_load_dwordx4 v12, s[12:15], s40 offen lds
    s_add_u32 m0, s33, 33792
    s_mov_b32 s40, 557056
    buffer_load_dwordx4 v12, s[12:15], s40 offen lds
    s_add_u32 m0, s33, 34816
    s_mov_b32 s40, 589824
    buffer_load_dwordx4 v12, s[12:15], s40 offen lds
    s_add_u32 m0, s33, 35840
    s_mov_b32 s40, 622592
    buffer_load_dwordx4 v12, s[12:15], s40 offen lds
    s_add_u32 m0, s32, 49152
    s_mov_b32 s40, 256
    buffer_load_dwordx4 v10, s[8:11], s40 offen lds
    s_add_u32 m0, s32, 50176
    s_mov_b32 s40, 256
    buffer_load_dwordx4 v11, s[8:11], s40 offen lds
    s_add_u32 m0, s33, 57344
    s_mov_b32 s40, 1048576
    buffer_load_dwordx4 v12, s[12:15], s40 offen lds
    s_add_u32 m0, s33, 58368
    s_mov_b32 s40, 1081344
    buffer_load_dwordx4 v12, s[12:15], s40 offen lds
    s_add_u32 m0, s33, 59392
    s_mov_b32 s40, 1114112
    buffer_load_dwordx4 v12, s[12:15], s40 offen lds
    s_add_u32 m0, s33, 60416
    s_mov_b32 s40, 1146880
    buffer_load_dwordx4 v12, s[12:15], s40 offen lds
    s_waitcnt vmcnt(12)
    s_barrier
    s_add_u32 m0, s32, 73728
    s_mov_b32 s40, 384
    buffer_load_dwordx4 v10, s[8:11], s40 offen lds
    s_add_u32 m0, s32, 74752
    s_mov_b32 s40, 384
    buffer_load_dwordx4 v11, s[8:11], s40 offen lds
    s_add_u32 m0, s33, 81920
    s_mov_b32 s40, 1572864
    buffer_load_dwordx4 v12, s[12:15], s40 offen lds
    s_add_u32 m0, s33, 82944
    s_mov_b32 s40, 1605632
    buffer_load_dwordx4 v12, s[12:15], s40 offen lds
    s_add_u32 m0, s33, 83968
    s_mov_b32 s40, 1638400
    buffer_load_dwordx4 v12, s[12:15], s40 offen lds
    s_add_u32 m0, s33, 84992
    s_mov_b32 s40, 1671168
    buffer_load_dwordx4 v12, s[12:15], s40 offen lds
    ds_read_b128 v[32:35], v16 offset:0
    ds_read_b64_tr_b16 v[36:37], v24 offset:0
    ds_read_b64_tr_b16 v[38:39], v24 offset:1024
    ds_read_b64_tr_b16 v[40:41], v25 offset:0
    ds_read_b64_tr_b16 v[42:43], v25 offset:1024
    ds_read_b128 v[44:47], v17 offset:0
    ds_read_b64_tr_b16 v[48:49], v24 offset:4096
    ds_read_b64_tr_b16 v[50:51], v24 offset:5120
    ds_read_b64_tr_b16 v[52:53], v25 offset:4096
    ds_read_b64_tr_b16 v[54:55], v25 offset:5120
    s_waitcnt lgkmcnt(5)
    v_mfma_f32_32x32x16_bf16 v[64:79], v[36:39], v[32:35], v[64:79]
    v_mfma_f32_32x32x16_bf16 v[80:95], v[40:43], v[32:35], v[80:95]
    ds_read_b128 v[32:35], v18 offset:0
    ds_read_b64_tr_b16 v[36:37], v24 offset:8192
    ds_read_b64_tr_b16 v[38:39], v24 offset:9216
    ds_read_b64_tr_b16 v[40:41], v25 offset:8192
    ds_read_b64_tr_b16 v[42:43], v25 offset:9216
    s_waitcnt lgkmcnt(5)
    v_mfma_f32_32x32x16_bf16 v[64:79], v[48:51], v[44:47], v[64:79]
    v_mfma_f32_32x32x16_bf16 v[80:95], v[52:55], v[44:47], v[80:95]
    ds_read_b128 v[44:47], v19 offset:0
    ds_read_b64_tr_b16 v[48:49], v24 offset:12288
    ds_read_b64_tr_b16 v[50:51], v24 offset:13312
    ds_read_b64_tr_b16 v[52:53], v25 offset:12288
    ds_read_b64_tr_b16 v[54:55], v25 offset:13312
    s_waitcnt lgkmcnt(5)
    v_mfma_f32_32x32x16_bf16 v[64:79], v[36:39], v[32:35], v[64:79]
    v_mfma_f32_32x32x16_bf16 v[80:95], v[40:43], v[32:35], v[80:95]
    s_waitcnt lgkmcnt(0)
    v_mfma_f32_32x32x16_bf16 v[64:79], v[48:51], v[44:47], v[64:79]
    v_mfma_f32_32x32x16_bf16 v[80:95], v[52:55], v[44:47], v[80:95]
    s_waitcnt vmcnt(12)
    s_barrier
    s_add_u32 m0, s32, 0
    s_mov_b32 s40, 512
    buffer_load_dwordx4 v10, s[8:11], s40 offen lds
    s_add_u32 m0, s32, 1024
    s_mov_b32 s40, 512
    buffer_load_dwordx4 v11, s[8:11], s40 offen lds
    s_add_u32 m0, s33, 8192
    s_mov_b32 s40, 2097152
    buffer_load_dwordx4 v12, s[12:15], s40 offen lds
    s_add_u32 m0, s33, 9216
    s_mov_b32 s40, 2129920
    buffer_load_dwordx4 v12, s[12:15], s40 offen lds
    s_add_u32 m0, s33, 10240
    s_mov_b32 s40, 2162688
    buffer_load_dwordx4 v12, s[12:15], s40 offen lds
    s_add_u32 m0, s33, 11264
    s_mov_b32 s40, 2195456
    buffer_load_dwordx4 v12, s[12:15], s40 offen lds
    ds_read_b128 v[32:35], v16 offset:24576
    ds_read_b64_tr_b16 v[36:37], v24 offset:24576
    ds_read_b64_tr_b16 v[38:39], v24 offset:25600
    ds_read_b64_tr_b16 v[40:41], v25 offset:24576
    ds_read_b64_tr_b16 v[42:43], v25 offset:25600
    ds_read_b128 v[44:47], v17 offset:24576
    ds_read_b64_tr_b16 v[48:49], v24 offset:28672
    ds_read_b64_tr_b16 v[50:51], v24 offset:29696
    ds_read_b64_tr_b16 v[52:53], v25 offset:28672
    ds_read_b64_tr_b16 v[54:55], v25 offset:29696
    s_waitcnt lgkmcnt(5)
    v_mfma_f32_32x32x16_bf16 v[64:79], v[36:39], v[32:35], v[64:79]
    v_mfma_f32_32x32x16_bf16 v[80:95], v[40:43], v[32:35], v[80:95]
    ds_read_b128 v[32:35], v18 offset:24576
    ds_read_b64_tr_b16 v[36:37], v24 offset:32768
    ds_read_b64_tr_b16 v[38:39], v24 offset:33792
    ds_read_b64_tr_b16 v[40:41], v25 offset:32768
    ds_read_b64_tr_b16 v[42:43], v25 offset:33792
    s_waitcnt lgkmcnt(5)
    v_mfma_f32_32x32x16_bf16 v[64:79], v[48:51], v[44:47], v[64:79]
    v_mfma_f32_32x32x16_bf16 v[80:95], v[52:55], v[44:47], v[80:95]
    ds_read_b128 v[44:47], v19 offset:24576
    ds_read_b64_tr_b16 v[48:49], v24 offset:36864
    ds_read_b64_tr_b16 v[50:51], v24 offset:37888
    ds_read_b64_tr_b16 v[52:53], v25 offset:36864
    ds_read_b64_tr_b16 v[54:55], v25 offset:37888
    s_waitcnt lgkmcnt(5)
    v_mfma_f32_32x32x16_bf16 v[64:79], v[36:39], v[32:35], v[64:79]
    v_mfma_f32_32x32x16_bf16 v[80:95], v[40:43], v[32:35], v[80:95]
    s_waitcnt lgkmcnt(0)
    v_mfma_f32_32x32x16_bf16 v[64:79], v[48:51], v[44:47], v[64:79]
    v_mfma_f32_32x32x16_bf16 v[80:95], v[52:55], v[44:47], v[80:95]
    s_waitcnt vmcnt(12)
    s_barrier
    s_add_u32 m0, s32, 24576
    s_mov_b32 s40, 640
    buffer_load_dwordx4 v10, s[8:11], s40 offen lds
    s_add_u32 m0, s32, 25600
    s_mov_b32 s40, 640
    buffer_load_dwordx4 v11, s[8:11], s40 offen lds
    s_add_u32 m0, s33, 32768
    s_mov_b32 s40, 2621440
    buffer_load_dwordx4 v12, s[12:15], s40 offen lds
    s_add_u32 m0, s33, 33792
    s_mov_b32 s40, 2654208
    buffer_load_dwordx4 v12, s[12:15], s40 offen lds
    s_add_u32 m0, s33, 34816
    s_mov_b32 s40, 2686976
    buffer_load_dwordx4 v12, s[12:15], s40 offen lds
    s_add_u32 m0, s33, 35840
    s_mov_b32 s40, 2719744
    buffer_load_dwordx4 v12, s[12:15], s40 offen lds
    ds_read_b128 v[32:35], v20 offset:0
    ds_read_b64_tr_b16 v[36:37], v26 offset:0
    ds_read_b64_tr_b16 v[38:39], v26 offset:1024
    ds_read_b64_tr_b16 v[40:41], v27 offset:0
    ds_read_b64_tr_b16 v[42:43], v27 offset:1024
    ds_read_b128 v[44:47], v21 offset:0
    ds_read_b64_tr_b16 v[48:49], v26 offset:4096
    ds_read_b64_tr_b16 v[50:51], v26 offset:5120
    ds_read_b64_tr_b16 v[52:53], v27 offset:4096
    ds_read_b64_tr_b16 v[54:55], v27 offset:5120
    s_waitcnt lgkmcnt(5)
    v_mfma_f32_32x32x16_bf16 v[64:79], v[36:39], v[32:35], v[64:79]
    v_mfma_f32_32x32x16_bf16 v[80:95], v[40:43], v[32:35], v[80:95]
    ds_read_b128 v[32:35], v22 offset:0
    ds_read_b64_tr_b16 v[36:37], v26 offset:8192
    ds_read_b64_tr_b16 v[38:39], v26 offset:9216
    ds_read_b64_tr_b16 v[40:41], v27 offset:8192
    ds_read_b64_tr_b16 v[42:43], v27 offset:9216
    s_waitcnt lgkmcnt(5)
    v_mfma_f32_32x32x16_bf16 v[64:79], v[48:51], v[44:47], v[64:79]
    v_mfma_f32_32x32x16_bf16 v[80:95], v[52:55], v[44:47], v[80:95]
    ds_read_b128 v[44:47], v23 offset:0
    ds_read_b64_tr_b16 v[48:49], v26 offset:12288
    ds_read_b64_tr_b16 v[50:51], v26 offset:13312
    ds_read_b64_tr_b16 v[52:53], v27 offset:12288
    ds_read_b64_tr_b16 v[54:55], v27 offset:13312
    s_waitcnt lgkmcnt(5)
    v_mfma_f32_32x32x16_bf16 v[64:79], v[36:39], v[32:35], v[64:79]
    v_mfma_f32_32x32x16_bf16 v[80:95], v[40:43], v[32:35], v[80:95]
    s_waitcnt lgkmcnt(0)
    v_mfma_f32_32x32x16_bf16 v[64:79], v[48:51], v[44:47], v[64:79]
    v_mfma_f32_32x32x16_bf16 v[80:95], v[52:55], v[44:47], v[80:95]
    s_waitcnt vmcnt(12)
    s_barrier
    s_add_u32 m0, s32, 49152
    s_mov_b32 s40, 768
    buffer_load_dwordx4 v10, s[8:11], s40 offen lds
    s_add_u32 m0, s32, 50176
    s_mov_b32 s40, 768
    buffer_load_dwordx4 v11, s[8:11], s40 offen lds
    s_add_u32 m0, s33, 57344
    s_mov_b32 s40, 3145728
    buffer_load_dwordx4 v12, s[12:15], s40 offen lds
    s_add_u32 m0, s33, 58368
    s_mov_b32 s40, 3178496
    buffer_load_dwordx4 v12, s[12:15], s40 offen lds
    s_add_u32 m0, s33, 59392
    s_mov_b32 s40, 3211264
    buffer_load_dwordx4 v12, s[12:15], s40 offen lds
    s_add_u32 m0, s33, 60416
    s_mov_b32 s40, 3244032
    buffer_load_dwordx4 v12, s[12:15], s40 offen lds
    ds_read_b128 v[32:35], v20 offset:24576
    ds_read_b64_tr_b16 v[36:37], v26 offset:24576
    ds_read_b64_tr_b16 v[38:39], v26 offset:25600
    ds_read_b64_tr_b16 v[40:41], v27 offset:24576
    ds_read_b64_tr_b16 v[42:43], v27 offset:25600
    ds_read_b128 v[44:47], v21 offset:24576
    ds_read_b64_tr_b16 v[48:49], v26 offset:28672
    ds_read_b64_tr_b16 v[50:51], v26 offset:29696
    ds_read_b64_tr_b16 v[52:53], v27 offset:28672
    ds_read_b64_tr_b16 v[54:55], v27 offset:29696
    s_waitcnt lgkmcnt(5)
    v_mfma_f32_32x32x16_bf16 v[64:79], v[36:39], v[32:35], v[64:79]
    v_mfma_f32_32x32x16_bf16 v[80:95], v[40:43], v[32:35], v[80:95]
    ds_read_b128 v[32:35], v22 offset:24576
    ds_read_b64_tr_b16 v[36:37], v26 offset:32768
    ds_read_b64_tr_b16 v[38:39], v26 offset:33792
    ds_read_b64_tr_b16 v[40:41], v27 offset:32768
    ds_read_b64_tr_b16 v[42:43], v27 offset:33792
    s_waitcnt lgkmcnt(5)
    v_mfma_f32_32x32x16_bf16 v[64:79], v[48:51], v[44:47], v[64:79]
    v_mfma_f32_32x32x16_bf16 v[80:95], v[52:55], v[44:47], v[80:95]
    ds_read_b128 v[44:47], v23 offset:24576
    ds_read_b64_tr_b16 v[48:49], v26 offset:36864
    ds_read_b64_tr_b16 v[50:51], v26 offset:37888
    ds_read_b64_tr_b16 v[52:53], v27 offset:36864
    ds_read_b64_tr_b16 v[54:55], v27 offset:37888
    s_waitcnt lgkmcnt(5)
    v_mfma_f32_32x32x16_bf16 v[64:79], v[36:39], v[32:35], v[64:79]
    v_mfma_f32_32x32x16_bf16 v[80:95], v[40:43], v[32:35], v[80:95]
    s_waitcnt lgkmcnt(0)
    v_mfma_f32_32x32x16_bf16 v[64:79], v[48:51], v[44:47], v[64:79]
    v_mfma_f32_32x32x16_bf16 v[80:95], v[52:55], v[44:47], v[80:95]
    s_waitcnt vmcnt(12)
    s_barrier
    s_add_u32 m0, s32, 73728
    s_mov_b32 s40, 896
    buffer_load_dwordx4 v10, s[8:11], s40 offen lds
    s_add_u32 m0, s32, 74752
    s_mov_b32 s40, 896
    buffer_load_dwordx4 v11, s[8:11], s40 offen lds
    s_add_u32 m0, s33, 81920
    s_mov_b32 s40, 3670016
    buffer_load_dwordx4 v12, s[12:15], s40 offen lds
    s_add_u32 m0, s33, 82944
    s_mov_b32 s40, 3702784
    buffer_load_dwordx4 v12, s[12:15], s40 offen lds
    s_add_u32 m0, s33, 83968
    s_mov_b32 s40, 3735552
    buffer_load_dwordx4 v12, s[12:15], s40 offen lds
    s_add_u32 m0, s33, 84992
    s_mov_b32 s40, 3768320
    buffer_load_dwordx4 v12, s[12:15], s40 offen lds
    ds_read_b128 v[32:35], v16 offset:0
    ds_read_b64_tr_b16 v[36:37], v24 offset:0
    ds_read_b64_tr_b16 v[38:39], v24 offset:1024
    ds_read_b64_tr_b16 v[40:41], v25 offset:0
    ds_read_b64_tr_b16 v[42:43], v25 offset:1024
    ds_read_b128 v[44:47], v17 offset:0
    ds_read_b64_tr_b16 v[48:49], v24 offset:4096
    ds_read_b64_tr_b16 v[50:51], v24 offset:5120
    ds_read_b64_tr_b16 v[52:53], v25 offset:4096
    ds_read_b64_tr_b16 v[54:55], v25 offset:5120
    s_waitcnt lgkmcnt(5)
    v_mfma_f32_32x32x16_bf16 v[64:79], v[36:39], v[32:35], v[64:79]
    v_mfma_f32_32x32x16_bf16 v[80:95], v[40:43], v[32:35], v[80:95]
    ds_read_b128 v[32:35], v18 offset:0
    ds_read_b64_tr_b16 v[36:37], v24 offset:8192
    ds_read_b64_tr_b16 v[38:39], v24 offset:9216
    ds_read_b64_tr_b16 v[40:41], v25 offset:8192
    ds_read_b64_tr_b16 v[42:43], v25 offset:9216
    s_waitcnt lgkmcnt(5)
    v_mfma_f32_32x32x16_bf16 v[64:79], v[48:51], v[44:47], v[64:79]
    v_mfma_f32_32x32x16_bf16 v[80:95], v[52:55], v[44:47], v[80:95]
    ds_read_b128 v[44:47], v19 offset:0
    ds_read_b64_tr_b16 v[48:49], v24 offset:12288
    ds_read_b64_tr_b16 v[50:51], v24 offset:13312
    ds_read_b64_tr_b16 v[52:53], v25 offset:12288
    ds_read_b64_tr_b16 v[54:55], v25 offset:13312
    s_waitcnt lgkmcnt(5)
    v_mfma_f32_32x32x16_bf16 v[64:79], v[36:39], v[32:35], v[64:79]
    v_mfma_f32_32x32x16_bf16 v[80:95], v[40:43], v[32:35], v[80:95]
    s_waitcnt lgkmcnt(0)
    v_mfma_f32_32x32x16_bf16 v[64:79], v[48:51], v[44:47], v[64:79]
    v_mfma_f32_32x32x16_bf16 v[80:95], v[52:55], v[44:47], v[80:95]
    s_waitcnt vmcnt(12)
    s_barrier
    s_add_u32 m0, s32, 0
    s_mov_b32 s40, 1024
    buffer_load_dwordx4 v10, s[8:11], s40 offen lds
    s_add_u32 m0, s32, 1024
    s_mov_b32 s40, 1024
    buffer_load_dwordx4 v11, s[8:11], s40 offen lds
    s_add_u32 m0, s33, 8192
    s_mov_b32 s40, 4194304
    buffer_load_dwordx4 v12, s[12:15], s40 offen lds
    s_add_u32 m0, s33, 9216
    s_mov_b32 s40, 4227072
    buffer_load_dwordx4 v12, s[12:15], s40 offen lds
    s_add_u32 m0, s33, 10240
    s_mov_b32 s40, 4259840
    buffer_load_dwordx4 v12, s[12:15], s40 offen lds
    s_add_u32 m0, s33, 11264
    s_mov_b32 s40, 4292608
    buffer_load_dwordx4 v12, s[12:15], s40 offen lds
    ds_read_b128 v[32:35], v16 offset:24576
    ds_read_b64_tr_b16 v[36:37], v24 offset:24576
    ds_read_b64_tr_b16 v[38:39], v24 offset:25600
    ds_read_b64_tr_b16 v[40:41], v25 offset:24576
    ds_read_b64_tr_b16 v[42:43], v25 offset:25600
    ds_read_b128 v[44:47], v17 offset:24576
    ds_read_b64_tr_b16 v[48:49], v24 offset:28672
    ds_read_b64_tr_b16 v[50:51], v24 offset:29696
    ds_read_b64_tr_b16 v[52:53], v25 offset:28672
    ds_read_b64_tr_b16 v[54:55], v25 offset:29696
    s_waitcnt lgkmcnt(5)
    v_mfma_f32_32x32x16_bf16 v[64:79], v[36:39], v[32:35], v[64:79]
    v_mfma_f32_32x32x16_bf16 v[80:95], v[40:43], v[32:35], v[80:95]
    ds_read_b128 v[32:35], v18 offset:24576
    ds_read_b64_tr_b16 v[36:37], v24 offset:32768
    ds_read_b64_tr_b16 v[38:39], v24 offset:33792
    ds_read_b64_tr_b16 v[40:41], v25 offset:32768
    ds_read_b64_tr_b16 v[42:43], v25 offset:33792
    s_waitcnt lgkmcnt(5)
    v_mfma_f32_32x32x16_bf16 v[64:79], v[48:51], v[44:47], v[64:79]
    v_mfma_f32_32x32x16_bf16 v[80:95], v[52:55], v[44:47], v[80:95]
    ds_read_b128 v[44:47], v19 offset:24576
    ds_read_b64_tr_b16 v[48:49], v24 offset:36864
    ds_read_b64_tr_b16 v[50:51], v24 offset:37888
    ds_read_b64_tr_b16 v[52:53], v25 offset:36864
    ds_read_b64_tr_b16 v[54:55], v25 offset:37888
    s_waitcnt lgkmcnt(5)
    v_mfma_f32_32x32x16_bf16 v[64:79], v[36:39], v[32:35], v[64:79]
    v_mfma_f32_32x32x16_bf16 v[80:95], v[40:43], v[32:35], v[80:95]
    s_waitcnt lgkmcnt(0)
    v_mfma_f32_32x32x16_bf16 v[64:79], v[48:51], v[44:47], v[64:79]
    v_mfma_f32_32x32x16_bf16 v[80:95], v[52:55], v[44:47], v[80:95]
    s_waitcnt vmcnt(12)
    s_barrier
    s_add_u32 m0, s32, 24576
    s_mov_b32 s40, 1152
    buffer_load_dwordx4 v10, s[8:11], s40 offen lds
    s_add_u32 m0, s32, 25600
    s_mov_b32 s40, 1152
    buffer_load_dwordx4 v11, s[8:11], s40 offen lds
    s_add_u32 m0, s33, 32768
    s_mov_b32 s40, 4718592
    buffer_load_dwordx4 v12, s[12:15], s40 offen lds
    s_add_u32 m0, s33, 33792
    s_mov_b32 s40, 4751360
    buffer_load_dwordx4 v12, s[12:15], s40 offen lds
    s_add_u32 m0, s33, 34816
    s_mov_b32 s40, 4784128
    buffer_load_dwordx4 v12, s[12:15], s40 offen lds
    s_add_u32 m0, s33, 35840
    s_mov_b32 s40, 4816896
    buffer_load_dwordx4 v12, s[12:15], s40 offen lds
    ds_read_b128 v[32:35], v20 offset:0
    ds_read_b64_tr_b16 v[36:37], v26 offset:0
    ds_read_b64_tr_b16 v[38:39], v26 offset:1024
    ds_read_b64_tr_b16 v[40:41], v27 offset:0
    ds_read_b64_tr_b16 v[42:43], v27 offset:1024
    ds_read_b128 v[44:47], v21 offset:0
    ds_read_b64_tr_b16 v[48:49], v26 offset:4096
    ds_read_b64_tr_b16 v[50:51], v26 offset:5120
    ds_read_b64_tr_b16 v[52:53], v27 offset:4096
    ds_read_b64_tr_b16 v[54:55], v27 offset:5120
    s_waitcnt lgkmcnt(5)
    v_mfma_f32_32x32x16_bf16 v[64:79], v[36:39], v[32:35], v[64:79]
    v_mfma_f32_32x32x16_bf16 v[80:95], v[40:43], v[32:35], v[80:95]
    ds_read_b128 v[32:35], v22 offset:0
    ds_read_b64_tr_b16 v[36:37], v26 offset:8192
    ds_read_b64_tr_b16 v[38:39], v26 offset:9216
    ds_read_b64_tr_b16 v[40:41], v27 offset:8192
    ds_read_b64_tr_b16 v[42:43], v27 offset:9216
    s_waitcnt lgkmcnt(5)
    v_mfma_f32_32x32x16_bf16 v[64:79], v[48:51], v[44:47], v[64:79]
    v_mfma_f32_32x32x16_bf16 v[80:95], v[52:55], v[44:47], v[80:95]
    ds_read_b128 v[44:47], v23 offset:0
    ds_read_b64_tr_b16 v[48:49], v26 offset:12288
    ds_read_b64_tr_b16 v[50:51], v26 offset:13312
    ds_read_b64_tr_b16 v[52:53], v27 offset:12288
    ds_read_b64_tr_b16 v[54:55], v27 offset:13312
    s_waitcnt lgkmcnt(5)
    v_mfma_f32_32x32x16_bf16 v[64:79], v[36:39], v[32:35], v[64:79]
    v_mfma_f32_32x32x16_bf16 v[80:95], v[40:43], v[32:35], v[80:95]
    s_waitcnt lgkmcnt(0)
    v_mfma_f32_32x32x16_bf16 v[64:79], v[48:51], v[44:47], v[64:79]
    v_mfma_f32_32x32x16_bf16 v[80:95], v[52:55], v[44:47], v[80:95]
    s_waitcnt vmcnt(12)
    s_barrier
    s_add_u32 m0, s32, 49152
    s_mov_b32 s40, 1280
    buffer_load_dwordx4 v10, s[8:11], s40 offen lds
    s_add_u32 m0, s32, 50176
    s_mov_b32 s40, 1280
    buffer_load_dwordx4 v11, s[8:11], s40 offen lds
    s_add_u32 m0, s33, 57344
    s_mov_b32 s40, 5242880
    buffer_load_dwordx4 v12, s[12:15], s40 offen lds
    s_add_u32 m0, s33, 58368
    s_mov_b32 s40, 5275648
    buffer_load_dwordx4 v12, s[12:15], s40 offen lds
    s_add_u32 m0, s33, 59392
    s_mov_b32 s40, 5308416
    buffer_load_dwordx4 v12, s[12:15], s40 offen lds
    s_add_u32 m0, s33, 60416
    s_mov_b32 s40, 5341184
    buffer_load_dwordx4 v12, s[12:15], s40 offen lds
    ds_read_b128 v[32:35], v20 offset:24576
    ds_read_b64_tr_b16 v[36:37], v26 offset:24576
    ds_read_b64_tr_b16 v[38:39], v26 offset:25600
    ds_read_b64_tr_b16 v[40:41], v27 offset:24576
    ds_read_b64_tr_b16 v[42:43], v27 offset:25600
    ds_read_b128 v[44:47], v21 offset:24576
    ds_read_b64_tr_b16 v[48:49], v26 offset:28672
    ds_read_b64_tr_b16 v[50:51], v26 offset:29696
    ds_read_b64_tr_b16 v[52:53], v27 offset:28672
    ds_read_b64_tr_b16 v[54:55], v27 offset:29696
    s_waitcnt lgkmcnt(5)
    v_mfma_f32_32x32x16_bf16 v[64:79], v[36:39], v[32:35], v[64:79]
    v_mfma_f32_32x32x16_bf16 v[80:95], v[40:43], v[32:35], v[80:95]
    ds_read_b128 v[32:35], v22 offset:24576
    ds_read_b64_tr_b16 v[36:37], v26 offset:32768
    ds_read_b64_tr_b16 v[38:39], v26 offset:33792
    ds_read_b64_tr_b16 v[40:41], v27 offset:32768
    ds_read_b64_tr_b16 v[42:43], v27 offset:33792
    s_waitcnt lgkmcnt(5)
    v_mfma_f32_32x32x16_bf16 v[64:79], v[48:51], v[44:47], v[64:79]
    v_mfma_f32_32x32x16_bf16 v[80:95], v[52:55], v[44:47], v[80:95]
    ds_read_b128 v[44:47], v23 offset:24576
    ds_read_b64_tr_b16 v[48:49], v26 offset:36864
    ds_read_b64_tr_b16 v[50:51], v26 offset:37888
    ds_read_b64_tr_b16 v[52:53], v27 offset:36864
    ds_read_b64_tr_b16 v[54:55], v27 offset:37888
    s_waitcnt lgkmcnt(5)
    v_mfma_f32_32x32x16_bf16 v[64:79], v[36:39], v[32:35], v[64:79]
    v_mfma_f32_32x32x16_bf16 v[80:95], v[40:43], v[32:35], v[80:95]
    s_waitcnt lgkmcnt(0)
    v_mfma_f32_32x32x16_bf16 v[64:79], v[48:51], v[44:47], v[64:79]
    v_mfma_f32_32x32x16_bf16 v[80:95], v[52:55], v[44:47], v[80:95]
    s_waitcnt vmcnt(12)
    s_barrier
    s_add_u32 m0, s32, 73728
    s_mov_b32 s40, 1408
    buffer_load_dwordx4 v10, s[8:11], s40 offen lds
    s_add_u32 m0, s32, 74752
    s_mov_b32 s40, 1408
    buffer_load_dwordx4 v11, s[8:11], s40 offen lds
    s_add_u32 m0, s33, 81920
    s_mov_b32 s40, 5767168
    buffer_load_dwordx4 v12, s[12:15], s40 offen lds
    s_add_u32 m0, s33, 82944
    s_mov_b32 s40, 5799936
    buffer_load_dwordx4 v12, s[12:15], s40 offen lds
    s_add_u32 m0, s33, 83968
    s_mov_b32 s40, 5832704
    buffer_load_dwordx4 v12, s[12:15], s40 offen lds
    s_add_u32 m0, s33, 84992
    s_mov_b32 s40, 5865472
    buffer_load_dwordx4 v12, s[12:15], s40 offen lds
    ds_read_b128 v[32:35], v16 offset:0
    ds_read_b64_tr_b16 v[36:37], v24 offset:0
    ds_read_b64_tr_b16 v[38:39], v24 offset:1024
    ds_read_b64_tr_b16 v[40:41], v25 offset:0
    ds_read_b64_tr_b16 v[42:43], v25 offset:1024
    ds_read_b128 v[44:47], v17 offset:0
    ds_read_b64_tr_b16 v[48:49], v24 offset:4096
    ds_read_b64_tr_b16 v[50:51], v24 offset:5120
    ds_read_b64_tr_b16 v[52:53], v25 offset:4096
    ds_read_b64_tr_b16 v[54:55], v25 offset:5120
    s_waitcnt lgkmcnt(5)
    v_mfma_f32_32x32x16_bf16 v[64:79], v[36:39], v[32:35], v[64:79]
    v_mfma_f32_32x32x16_bf16 v[80:95], v[40:43], v[32:35], v[80:95]
    ds_read_b128 v[32:35], v18 offset:0
    ds_read_b64_tr_b16 v[36:37], v24 offset:8192
    ds_read_b64_tr_b16 v[38:39], v24 offset:9216
    ds_read_b64_tr_b16 v[40:41], v25 offset:8192
    ds_read_b64_tr_b16 v[42:43], v25 offset:9216
    s_waitcnt lgkmcnt(5)
    v_mfma_f32_32x32x16_bf16 v[64:79], v[48:51], v[44:47], v[64:79]
    v_mfma_f32_32x32x16_bf16 v[80:95], v[52:55], v[44:47], v[80:95]
    ds_read_b128 v[44:47], v19 offset:0
    ds_read_b64_tr_b16 v[48:49], v24 offset:12288
    ds_read_b64_tr_b16 v[50:51], v24 offset:13312
    ds_read_b64_tr_b16 v[52:53], v25 offset:12288
    ds_read_b64_tr_b16 v[54:55], v25 offset:13312
    s_waitcnt lgkmcnt(5)
    v_mfma_f32_32x32x16_bf16 v[64:79], v[36:39], v[32:35], v[64:79]
    v_mfma_f32_32x32x16_bf16 v[80:95], v[40:43], v[32:35], v[80:95]
    s_waitcnt lgkmcnt(0)
    v_mfma_f32_32x32x16_bf16 v[64:79], v[48:51], v[44:47], v[64:79]
    v_mfma_f32_32x32x16_bf16 v[80:95], v[52:55], v[44:47], v[80:95]
    s_waitcnt vmcnt(12)
    s_barrier
    s_add_u32 m0, s32, 0
    s_mov_b32 s40, 1536
    buffer_load_dwordx4 v10, s[8:11], s40 offen lds
    s_add_u32 m0, s32, 1024
    s_mov_b32 s40, 1536
    buffer_load_dwordx4 v11, s[8:11], s40 offen lds
    s_add_u32 m0, s33, 8192
    s_mov_b32 s40, 6291456
    buffer_load_dwordx4 v12, s[12:15], s40 offen lds
    s_add_u32 m0, s33, 9216
    s_mov_b32 s40, 6324224
    buffer_load_dwordx4 v12, s[12:15], s40 offen lds
    s_add_u32 m0, s33, 10240
    s_mov_b32 s40, 6356992
    buffer_load_dwordx4 v12, s[12:15], s40 offen lds
    s_add_u32 m0, s33, 11264
    s_mov_b32 s40, 6389760
    buffer_load_dwordx4 v12, s[12:15], s40 offen lds
    ds_read_b128 v[32:35], v16 offset:24576
    ds_read_b64_tr_b16 v[36:37], v24 offset:24576
    ds_read_b64_tr_b16 v[38:39], v24 offset:25600
    ds_read_b64_tr_b16 v[40:41], v25 offset:24576
    ds_read_b64_tr_b16 v[42:43], v25 offset:25600
    ds_read_b128 v[44:47], v17 offset:24576
    ds_read_b64_tr_b16 v[48:49], v24 offset:28672
    ds_read_b64_tr_b16 v[50:51], v24 offset:29696
    ds_read_b64_tr_b16 v[52:53], v25 offset:28672
    ds_read_b64_tr_b16 v[54:55], v25 offset:29696
    s_waitcnt lgkmcnt(5)
    v_mfma_f32_32x32x16_bf16 v[64:79], v[36:39], v[32:35], v[64:79]
    v_mfma_f32_32x32x16_bf16 v[80:95], v[40:43], v[32:35], v[80:95]
    ds_read_b128 v[32:35], v18 offset:24576
    ds_read_b64_tr_b16 v[36:37], v24 offset:32768
    ds_read_b64_tr_b16 v[38:39], v24 offset:33792
    ds_read_b64_tr_b16 v[40:41], v25 offset:32768
    ds_read_b64_tr_b16 v[42:43], v25 offset:33792
    s_waitcnt lgkmcnt(5)
    v_mfma_f32_32x32x16_bf16 v[64:79], v[48:51], v[44:47], v[64:79]
    v_mfma_f32_32x32x16_bf16 v[80:95], v[52:55], v[44:47], v[80:95]
    ds_read_b128 v[44:47], v19 offset:24576
    ds_read_b64_tr_b16 v[48:49], v24 offset:36864
    ds_read_b64_tr_b16 v[50:51], v24 offset:37888
    ds_read_b64_tr_b16 v[52:53], v25 offset:36864
    ds_read_b64_tr_b16 v[54:55], v25 offset:37888
    s_waitcnt lgkmcnt(5)
    v_mfma_f32_32x32x16_bf16 v[64:79], v[36:39], v[32:35], v[64:79]
    v_mfma_f32_32x32x16_bf16 v[80:95], v[40:43], v[32:35], v[80:95]
    s_waitcnt lgkmcnt(0)
    v_mfma_f32_32x32x16_bf16 v[64:79], v[48:51], v[44:47], v[64:79]
    v_mfma_f32_32x32x16_bf16 v[80:95], v[52:55], v[44:47], v[80:95]
    s_waitcnt vmcnt(12)
    s_barrier
    s_add_u32 m0, s32, 24576
    s_mov_b32 s40, 1664
    buffer_load_dwordx4 v10, s[8:11], s40 offen lds
    s_add_u32 m0, s32, 25600
    s_mov_b32 s40, 1664
    buffer_load_dwordx4 v11, s[8:11], s40 offen lds
    s_add_u32 m0, s33, 32768
    s_mov_b32 s40, 6815744
    buffer_load_dwordx4 v12, s[12:15], s40 offen lds
    s_add_u32 m0, s33, 33792
    s_mov_b32 s40, 6848512
    buffer_load_dwordx4 v12, s[12:15], s40 offen lds
    s_add_u32 m0, s33, 34816
    s_mov_b32 s40, 6881280
    buffer_load_dwordx4 v12, s[12:15], s40 offen lds
    s_add_u32 m0, s33, 35840
    s_mov_b32 s40, 6914048
    buffer_load_dwordx4 v12, s[12:15], s40 offen lds
    ds_read_b128 v[32:35], v20 offset:0
    ds_read_b64_tr_b16 v[36:37], v26 offset:0
    ds_read_b64_tr_b16 v[38:39], v26 offset:1024
    ds_read_b64_tr_b16 v[40:41], v27 offset:0
    ds_read_b64_tr_b16 v[42:43], v27 offset:1024
    ds_read_b128 v[44:47], v21 offset:0
    ds_read_b64_tr_b16 v[48:49], v26 offset:4096
    ds_read_b64_tr_b16 v[50:51], v26 offset:5120
    ds_read_b64_tr_b16 v[52:53], v27 offset:4096
    ds_read_b64_tr_b16 v[54:55], v27 offset:5120
    s_waitcnt lgkmcnt(5)
    v_mfma_f32_32x32x16_bf16 v[64:79], v[36:39], v[32:35], v[64:79]
    v_mfma_f32_32x32x16_bf16 v[80:95], v[40:43], v[32:35], v[80:95]
    ds_read_b128 v[32:35], v22 offset:0
    ds_read_b64_tr_b16 v[36:37], v26 offset:8192
    ds_read_b64_tr_b16 v[38:39], v26 offset:9216
    ds_read_b64_tr_b16 v[40:41], v27 offset:8192
    ds_read_b64_tr_b16 v[42:43], v27 offset:9216
    s_waitcnt lgkmcnt(5)
    v_mfma_f32_32x32x16_bf16 v[64:79], v[48:51], v[44:47], v[64:79]
    v_mfma_f32_32x32x16_bf16 v[80:95], v[52:55], v[44:47], v[80:95]
    ds_read_b128 v[44:47], v23 offset:0
    ds_read_b64_tr_b16 v[48:49], v26 offset:12288
    ds_read_b64_tr_b16 v[50:51], v26 offset:13312
    ds_read_b64_tr_b16 v[52:53], v27 offset:12288
    ds_read_b64_tr_b16 v[54:55], v27 offset:13312
    s_waitcnt lgkmcnt(5)
    v_mfma_f32_32x32x16_bf16 v[64:79], v[36:39], v[32:35], v[64:79]
    v_mfma_f32_32x32x16_bf16 v[80:95], v[40:43], v[32:35], v[80:95]
    s_waitcnt lgkmcnt(0)
    v_mfma_f32_32x32x16_bf16 v[64:79], v[48:51], v[44:47], v[64:79]
    v_mfma_f32_32x32x16_bf16 v[80:95], v[52:55], v[44:47], v[80:95]
    s_waitcnt vmcnt(12)
    s_barrier
    s_add_u32 m0, s32, 49152
    s_mov_b32 s40, 1792
    buffer_load_dwordx4 v10, s[8:11], s40 offen lds
    s_add_u32 m0, s32, 50176
    s_mov_b32 s40, 1792
    buffer_load_dwordx4 v11, s[8:11], s40 offen lds
    s_add_u32 m0, s33, 57344
    s_mov_b32 s40, 7340032
    buffer_load_dwordx4 v12, s[12:15], s40 offen lds
    s_add_u32 m0, s33, 58368
    s_mov_b32 s40, 7372800
    buffer_load_dwordx4 v12, s[12:15], s40 offen lds
    s_add_u32 m0, s33, 59392
    s_mov_b32 s40, 7405568
    buffer_load_dwordx4 v12, s[12:15], s40 offen lds
    s_add_u32 m0, s33, 60416
    s_mov_b32 s40, 7438336
    buffer_load_dwordx4 v12, s[12:15], s40 offen lds
    ds_read_b128 v[32:35], v20 offset:24576
    ds_read_b64_tr_b16 v[36:37], v26 offset:24576
    ds_read_b64_tr_b16 v[38:39], v26 offset:25600
    ds_read_b64_tr_b16 v[40:41], v27 offset:24576
    ds_read_b64_tr_b16 v[42:43], v27 offset:25600
    ds_read_b128 v[44:47], v21 offset:24576
    ds_read_b64_tr_b16 v[48:49], v26 offset:28672
    ds_read_b64_tr_b16 v[50:51], v26 offset:29696
    ds_read_b64_tr_b16 v[52:53], v27 offset:28672
    ds_read_b64_tr_b16 v[54:55], v27 offset:29696
    s_waitcnt lgkmcnt(5)
    v_mfma_f32_32x32x16_bf16 v[64:79], v[36:39], v[32:35], v[64:79]
    v_mfma_f32_32x32x16_bf16 v[80:95], v[40:43], v[32:35], v[80:95]
    ds_read_b128 v[32:35], v22 offset:24576
    ds_read_b64_tr_b16 v[36:37], v26 offset:32768
    ds_read_b64_tr_b16 v[38:39], v26 offset:33792
    ds_read_b64_tr_b16 v[40:41], v27 offset:32768
    ds_read_b64_tr_b16 v[42:43], v27 offset:33792
    s_waitcnt lgkmcnt(5)
    v_mfma_f32_32x32x16_bf16 v[64:79], v[48:51], v[44:47], v[64:79]
    v_mfma_f32_32x32x16_bf16 v[80:95], v[52:55], v[44:47], v[80:95]
    ds_read_b128 v[44:47], v23 offset:24576
    ds_read_b64_tr_b16 v[48:49], v26 offset:36864
    ds_read_b64_tr_b16 v[50:51], v26 offset:37888
    ds_read_b64_tr_b16 v[52:53], v27 offset:36864
    ds_read_b64_tr_b16 v[54:55], v27 offset:37888
    s_waitcnt lgkmcnt(5)
    v_mfma_f32_32x32x16_bf16 v[64:79], v[36:39], v[32:35], v[64:79]
    v_mfma_f32_32x32x16_bf16 v[80:95], v[40:43], v[32:35], v[80:95]
    s_waitcnt lgkmcnt(0)
    v_mfma_f32_32x32x16_bf16 v[64:79], v[48:51], v[44:47], v[64:79]
    v_mfma_f32_32x32x16_bf16 v[80:95], v[52:55], v[44:47], v[80:95]
    s_waitcnt vmcnt(12)
    s_barrier
    s_add_u32 m0, s32, 73728
    s_mov_b32 s40, 1920
    buffer_load_dwordx4 v10, s[8:11], s40 offen lds
    s_add_u32 m0, s32, 74752
    s_mov_b32 s40, 1920
    buffer_load_dwordx4 v11, s[8:11], s40 offen lds
    s_add_u32 m0, s33, 81920
    s_mov_b32 s40, 7864320
    buffer_load_dwordx4 v12, s[12:15], s40 offen lds
    s_add_u32 m0, s33, 82944
    s_mov_b32 s40, 7897088
    buffer_load_dwordx4 v12, s[12:15], s40 offen lds
    s_add_u32 m0, s33, 83968
    s_mov_b32 s40, 7929856
    buffer_load_dwordx4 v12, s[12:15], s40 offen lds
    s_add_u32 m0, s33, 84992
    s_mov_b32 s40, 7962624
    buffer_load_dwordx4 v12, s[12:15], s40 offen lds
    ds_read_b128 v[32:35], v16 offset:0
    ds_read_b64_tr_b16 v[36:37], v24 offset:0
    ds_read_b64_tr_b16 v[38:39], v24 offset:1024
    ds_read_b64_tr_b16 v[40:41], v25 offset:0
    ds_read_b64_tr_b16 v[42:43], v25 offset:1024
    ds_read_b128 v[44:47], v17 offset:0
    ds_read_b64_tr_b16 v[48:49], v24 offset:4096
    ds_read_b64_tr_b16 v[50:51], v24 offset:5120
    ds_read_b64_tr_b16 v[52:53], v25 offset:4096
    ds_read_b64_tr_b16 v[54:55], v25 offset:5120
    s_waitcnt lgkmcnt(5)
    v_mfma_f32_32x32x16_bf16 v[64:79], v[36:39], v[32:35], v[64:79]
    v_mfma_f32_32x32x16_bf16 v[80:95], v[40:43], v[32:35], v[80:95]
    ds_read_b128 v[32:35], v18 offset:0
    ds_read_b64_tr_b16 v[36:37], v24 offset:8192
    ds_read_b64_tr_b16 v[38:39], v24 offset:9216
    ds_read_b64_tr_b16 v[40:41], v25 offset:8192
    ds_read_b64_tr_b16 v[42:43], v25 offset:9216
    s_waitcnt lgkmcnt(5)
    v_mfma_f32_32x32x16_bf16 v[64:79], v[48:51], v[44:47], v[64:79]
    v_mfma_f32_32x32x16_bf16 v[80:95], v[52:55], v[44:47], v[80:95]
    ds_read_b128 v[44:47], v19 offset:0
    ds_read_b64_tr_b16 v[48:49], v24 offset:12288
    ds_read_b64_tr_b16 v[50:51], v24 offset:13312
    ds_read_b64_tr_b16 v[52:53], v25 offset:12288
    ds_read_b64_tr_b16 v[54:55], v25 offset:13312
    s_waitcnt lgkmcnt(5)
    v_mfma_f32_32x32x16_bf16 v[64:79], v[36:39], v[32:35], v[64:79]
    v_mfma_f32_32x32x16_bf16 v[80:95], v[40:43], v[32:35], v[80:95]
    s_waitcnt lgkmcnt(0)
    v_mfma_f32_32x32x16_bf16 v[64:79], v[48:51], v[44:47], v[64:79]
    v_mfma_f32_32x32x16_bf16 v[80:95], v[52:55], v[44:47], v[80:95]
    s_waitcnt vmcnt(12)
    s_barrier
    ds_read_b128 v[32:35], v16 offset:24576
    ds_read_b64_tr_b16 v[36:37], v24 offset:24576
    ds_read_b64_tr_b16 v[38:39], v24 offset:25600
    ds_read_b64_tr_b16 v[40:41], v25 offset:24576
    ds_read_b64_tr_b16 v[42:43], v25 offset:25600
    ds_read_b128 v[44:47], v17 offset:24576
    ds_read_b64_tr_b16 v[48:49], v24 offset:28672
    ds_read_b64_tr_b16 v[50:51], v24 offset:29696
    ds_read_b64_tr_b16 v[52:53], v25 offset:28672
    ds_read_b64_tr_b16 v[54:55], v25 offset:29696
    s_waitcnt lgkmcnt(5)
    v_mfma_f32_32x32x16_bf16 v[64:79], v[36:39], v[32:35], v[64:79]
    v_mfma_f32_32x32x16_bf16 v[80:95], v[40:43], v[32:35], v[80:95]
    ds_read_b128 v[32:35], v18 offset:24576
    ds_read_b64_tr_b16 v[36:37], v24 offset:32768
    ds_read_b64_tr_b16 v[38:39], v24 offset:33792
    ds_read_b64_tr_b16 v[40:41], v25 offset:32768
    ds_read_b64_tr_b16 v[42:43], v25 offset:33792
    s_waitcnt lgkmcnt(5)
    v_mfma_f32_32x32x16_bf16 v[64:79], v[48:51], v[44:47], v[64:79]
    v_mfma_f32_32x32x16_bf16 v[80:95], v[52:55], v[44:47], v[80:95]
    ds_read_b128 v[44:47], v19 offset:24576
    ds_read_b64_tr_b16 v[48:49], v24 offset:36864
    ds_read_b64_tr_b16 v[50:51], v24 offset:37888
    ds_read_b64_tr_b16 v[52:53], v25 offset:36864
    ds_read_b64_tr_b16 v[54:55], v25 offset:37888
    s_waitcnt lgkmcnt(5)
    v_mfma_f32_32x32x16_bf16 v[64:79], v[36:39], v[32:35], v[64:79]
    v_mfma_f32_32x32x16_bf16 v[80:95], v[40:43], v[32:35], v[80:95]
    s_waitcnt lgkmcnt(0)
    v_mfma_f32_32x32x16_bf16 v[64:79], v[48:51], v[44:47], v[64:79]
    v_mfma_f32_32x32x16_bf16 v[80:95], v[52:55], v[44:47], v[80:95]
    s_waitcnt vmcnt(6)
    s_barrier
    ds_read_b128 v[32:35], v20 offset:0
    ds_read_b64_tr_b16 v[36:37], v26 offset:0
    ds_read_b64_tr_b16 v[38:39], v26 offset:1024
    ds_read_b64_tr_b16 v[40:41], v27 offset:0
    ds_read_b64_tr_b16 v[42:43], v27 offset:1024
    ds_read_b128 v[44:47], v21 offset:0
    ds_read_b64_tr_b16 v[48:49], v26 offset:4096
    ds_read_b64_tr_b16 v[50:51], v26 offset:5120
    ds_read_b64_tr_b16 v[52:53], v27 offset:4096
    ds_read_b64_tr_b16 v[54:55], v27 offset:5120
    s_waitcnt lgkmcnt(5)
    v_mfma_f32_32x32x16_bf16 v[64:79], v[36:39], v[32:35], v[64:79]
    v_mfma_f32_32x32x16_bf16 v[80:95], v[40:43], v[32:35], v[80:95]
    ds_read_b128 v[32:35], v22 offset:0
    ds_read_b64_tr_b16 v[36:37], v26 offset:8192
    ds_read_b64_tr_b16 v[38:39], v26 offset:9216
    ds_read_b64_tr_b16 v[40:41], v27 offset:8192
    ds_read_b64_tr_b16 v[42:43], v27 offset:9216
    s_waitcnt lgkmcnt(5)
    v_mfma_f32_32x32x16_bf16 v[64:79], v[48:51], v[44:47], v[64:79]
    v_mfma_f32_32x32x16_bf16 v[80:95], v[52:55], v[44:47], v[80:95]
    ds_read_b128 v[44:47], v23 offset:0
    ds_read_b64_tr_b16 v[48:49], v26 offset:12288
    ds_read_b64_tr_b16 v[50:51], v26 offset:13312
    ds_read_b64_tr_b16 v[52:53], v27 offset:12288
    ds_read_b64_tr_b16 v[54:55], v27 offset:13312
    s_waitcnt lgkmcnt(5)
    v_mfma_f32_32x32x16_bf16 v[64:79], v[36:39], v[32:35], v[64:79]
    v_mfma_f32_32x32x16_bf16 v[80:95], v[40:43], v[32:35], v[80:95]
    s_waitcnt lgkmcnt(0)
    v_mfma_f32_32x32x16_bf16 v[64:79], v[48:51], v[44:47], v[64:79]
    v_mfma_f32_32x32x16_bf16 v[80:95], v[52:55], v[44:47], v[80:95]
    s_waitcnt vmcnt(0)
    s_barrier
    ds_read_b128 v[32:35], v20 offset:24576
    ds_read_b64_tr_b16 v[36:37], v26 offset:24576
    ds_read_b64_tr_b16 v[38:39], v26 offset:25600
    ds_read_b64_tr_b16 v[40:41], v27 offset:24576
    ds_read_b64_tr_b16 v[42:43], v27 offset:25600
    ds_read_b128 v[44:47], v21 offset:24576
    ds_read_b64_tr_b16 v[48:49], v26 offset:28672
    ds_read_b64_tr_b16 v[50:51], v26 offset:29696
    ds_read_b64_tr_b16 v[52:53], v27 offset:28672
    ds_read_b64_tr_b16 v[54:55], v27 offset:29696
    s_waitcnt lgkmcnt(5)
    v_mfma_f32_32x32x16_bf16 v[64:79], v[36:39], v[32:35], v[64:79]
    v_mfma_f32_32x32x16_bf16 v[80:95], v[40:43], v[32:35], v[80:95]
    ds_read_b128 v[32:35], v22 offset:24576
    ds_read_b64_tr_b16 v[36:37], v26 offset:32768
    ds_read_b64_tr_b16 v[38:39], v26 offset:33792
    ds_read_b64_tr_b16 v[40:41], v27 offset:32768
    ds_read_b64_tr_b16 v[42:43], v27 offset:33792
    s_waitcnt lgkmcnt(5)
    v_mfma_f32_32x32x16_bf16 v[64:79], v[48:51], v[44:47], v[64:79]
    v_mfma_f32_32x32x16_bf16 v[80:95], v[52:55], v[44:47], v[80:95]
    ds_read_b128 v[44:47], v23 offset:24576
    ds_read_b64_tr_b16 v[48:49], v26 offset:36864
    ds_read_b64_tr_b16 v[50:51], v26 offset:37888
    ds_read_b64_tr_b16 v[52:53], v27 offset:36864
    ds_read_b64_tr_b16 v[54:55], v27 offset:37888
    s_waitcnt lgkmcnt(5)
    v_mfma_f32_32x32x16_bf16 v[64:79], v[36:39], v[32:35], v[64:79]
    v_mfma_f32_32x32x16_bf16 v[80:95], v[40:43], v[32:35], v[80:95]
    s_waitcnt lgkmcnt(0)
    v_mfma_f32_32x32x16_bf16 v[64:79], v[48:51], v[44:47], v[64:79]
    v_mfma_f32_32x32x16_bf16 v[80:95], v[52:55], v[44:47], v[80:95]
    s_nop 7
    s_nop 7
    v_cvt_pk_bf16_f32 v32, v64, v65
    v_cvt_pk_bf16_f32 v33, v66, v67
    v_cvt_pk_bf16_f32 v34, v68, v69
    v_cvt_pk_bf16_f32 v35, v70, v71
    v_cvt_pk_bf16_f32 v36, v72, v73
    v_cvt_pk_bf16_f32 v37, v74, v75
    v_cvt_pk_bf16_f32 v38, v76, v77
    v_cvt_pk_bf16_f32 v39, v78, v79
    v_cvt_pk_bf16_f32 v40, v80, v81
    v_cvt_pk_bf16_f32 v41, v82, v83
    v_cvt_pk_bf16_f32 v42, v84, v85
    v_cvt_pk_bf16_f32 v43, v86, v87
    v_cvt_pk_bf16_f32 v44, v88, v89
    v_cvt_pk_bf16_f32 v45, v90, v91
    v_cvt_pk_bf16_f32 v46, v92, v93
    v_cvt_pk_bf16_f32 v47, v94, v95
    v_and_b32 v2, 31, v1
    v_lshrrev_b32 v3, 5, v1
    v_and_b32 v4, 15, v2
    s_lshl_b32 s38, s37, 3
    v_xor_b32 v4, s38, v4
    v_lshlrev_b32 v4, 4, v4
    v_lshl_add_u32 v4, v2, 8, v4
    v_lshl_add_u32 v4, v3, 3, v4
    s_lshl_b32 s38, s36, 14
    s_add_u32 s38, s38, 98304
    v_add_u32 v4, s38, v4
    v_xor_b32 v5, 0, v4
    ds_read_b64 v[64:65], v5
    v_xor_b32 v5, 16, v4
    ds_read_b64 v[66:67], v5
    v_xor_b32 v5, 32, v4
    ds_read_b64 v[68:69], v5
    v_xor_b32 v5, 48, v4
    ds_read_b64 v[70:71], v5
    v_xor_b32 v5, 64, v4
    ds_read_b64 v[72:73], v5
    v_xor_b32 v5, 80, v4
    ds_read_b64 v[74:75], v5
    v_xor_b32 v5, 96, v4
    ds_read_b64 v[76:77], v5
    v_xor_b32 v5, 112, v4
    ds_read_b64 v[78:79], v5
    v_mov_b32 v96, 0
    v_mov_b32 v97, 0
    v_mov_b32 v98, 0
    v_mov_b32 v99, 0
    v_mov_b32 v100, 0
    v_mov_b32 v101, 0
    v_mov_b32 v102, 0
    v_mov_b32 v103, 0
    v_mov_b32 v104, 0
    v_mov_b32 v105, 0
    v_mov_b32 v106, 0
    v_mov_b32 v107, 0
    v_mov_b32 v108, 0
    v_mov_b32 v109, 0
    v_mov_b32 v110, 0
    v_mov_b32 v111, 0
    s_waitcnt lgkmcnt(0)
    v_mfma_f32_32x32x16_bf16 v[96:111], v[64:67], v[32:35], v[96:111]
    v_mfma_f32_32x32x16_bf16 v[96:111], v[68:71], v[36:39], v[96:111]
    v_mfma_f32_32x32x16_bf16 v[96:111], v[72:75], v[40:43], v[96:111]
    v_mfma_f32_32x32x16_bf16 v[96:111], v[76:79], v[44:47], v[96:111]
    s_nop 7
    s_nop 7
    s_barrier
    s_lshl_b32 s38, s28, 12
    v_lshlrev_b32 v5, 6, v1
    v_add_u32 v6, s38, v5
    ds_write_b128 v6, v[96:99] offset:0
    ds_write_b128 v6, v[100:103] offset:16
    ds_write_b128 v6, v[104:107] offset:32
    ds_write_b128 v6, v[108:111] offset:48
    s_xor_b32 s38, s28, 2
    s_lshl_b32 s38, s38, 12
    v_add_u32 v6, s38, v5
    s_waitcnt lgkmcnt(0)
    s_barrier
    ds_read_b128 v[64:67], v6 offset:0
    ds_read_b128 v[68:71], v6 offset:16
    ds_read_b128 v[72:75], v6 offset:32
    ds_read_b128 v[76:79], v6 offset:48
    s_waitcnt lgkmcnt(0)
    s_mov_b32 s38, 0x3db504f3
    s_mov_b32 s39, 0x3fb8aa3b
    s_mov_b32 s41, 0xffff0000
    v_add_f32 v96, v96, v64
    v_add_f32 v97, v97, v65
    v_add_f32 v98, v98, v66
    v_add_f32 v99, v99, v67
    v_add_f32 v100, v100, v68
    v_add_f32 v101, v101, v69
    v_add_f32 v102, v102, v70
    v_add_f32 v103, v103, v71
    v_add_f32 v104, v104, v72
    v_add_f32 v105, v105, v73
    v_add_f32 v106, v106, v74
    v_add_f32 v107, v107, v75
    v_add_f32 v108, v108, v76
    v_add_f32 v109, v109, v77
    v_add_f32 v110, v110, v78
    v_add_f32 v111, v111, v79
    v_cvt_pk_bf16_f32 v5, v96, v97
    v_lshlrev_b32 v6, 16, v5
    v_and_b32 v7, s41, v5
    v_mul_f32 v6, s38, v6
    v_mul_f32 v7, s38, v7
    v_cvt_pk_bf16_f32 v5, v6, v7
    v_lshlrev_b32 v96, 16, v5
    v_and_b32 v97, s41, v5
    v_cvt_pk_bf16_f32 v5, v98, v99
    v_lshlrev_b32 v6, 16, v5
    v_and_b32 v7, s41, v5
    v_mul_f32 v6, s38, v6
    v_mul_f32 v7, s38, v7
    v_cvt_pk_bf16_f32 v5, v6, v7
    v_lshlrev_b32 v98, 16, v5
    v_and_b32 v99, s41, v5
    v_cvt_pk_bf16_f32 v5, v100, v101
    v_lshlrev_b32 v6, 16, v5
    v_and_b32 v7, s41, v5
    v_mul_f32 v6, s38, v6
    v_mul_f32 v7, s38, v7
    v_cvt_pk_bf16_f32 v5, v6, v7
    v_lshlrev_b32 v100, 16, v5
    v_and_b32 v101, s41, v5
    v_cvt_pk_bf16_f32 v5, v102, v103
    v_lshlrev_b32 v6, 16, v5
    v_and_b32 v7, s41, v5
    v_mul_f32 v6, s38, v6
    v_mul_f32 v7, s38, v7
    v_cvt_pk_bf16_f32 v5, v6, v7
    v_lshlrev_b32 v102, 16, v5
    v_and_b32 v103, s41, v5
    v_cvt_pk_bf16_f32 v5, v104, v105
    v_lshlrev_b32 v6, 16, v5
    v_and_b32 v7, s41, v5
    v_mul_f32 v6, s38, v6
    v_mul_f32 v7, s38, v7
    v_cvt_pk_bf16_f32 v5, v6, v7
    v_lshlrev_b32 v104, 16, v5
    v_and_b32 v105, s41, v5
    v_cvt_pk_bf16_f32 v5, v106, v107
    v_lshlrev_b32 v6, 16, v5
    v_and_b32 v7, s41, v5
    v_mul_f32 v6, s38, v6
    v_mul_f32 v7, s38, v7
    v_cvt_pk_bf16_f32 v5, v6, v7
    v_lshlrev_b32 v106, 16, v5
    v_and_b32 v107, s41, v5
    v_cvt_pk_bf16_f32 v5, v108, v109
    v_lshlrev_b32 v6, 16, v5
    v_and_b32 v7, s41, v5
    v_mul_f32 v6, s38, v6
    v_mul_f32 v7, s38, v7
    v_cvt_pk_bf16_f32 v5, v6, v7
    v_lshlrev_b32 v108, 16, v5
    v_and_b32 v109, s41, v5
    v_cvt_pk_bf16_f32 v5, v110, v111
    v_lshlrev_b32 v6, 16, v5
    v_and_b32 v7, s41, v5
    v_mul_f32 v6, s38, v6
    v_mul_f32 v7, s38, v7
    v_cvt_pk_bf16_f32 v5, v6, v7
    v_lshlrev_b32 v110, 16, v5
    v_and_b32 v111, s41, v5
    v_max_f32 v5, v96, v97
    v_max_f32 v5, v5, v98
    v_max_f32 v5, v5, v99
    v_max_f32 v5, v5, v100
    v_max_f32 v5, v5, v101
    v_max_f32 v5, v5, v102
    v_max_f32 v5, v5, v103
    v_max_f32 v5, v5, v104
    v_max_f32 v5, v5, v105
    v_max_f32 v5, v5, v106
    v_max_f32 v5, v5, v107
    v_max_f32 v5, v5, v108
    v_max_f32 v5, v5, v109
    v_max_f32 v5, v5, v110
    v_max_f32 v5, v5, v111
    v_mov_b32 v6, v5
    s_nop 1
    v_permlane32_swap_b32 v5, v6
    v_max_f32 v5, v5, v6
    v_sub_f32 v96, v96, v5
    v_mul_f32 v96, s39, v96
    v_exp_f32 v96, v96
    v_sub_f32 v97, v97, v5
    v_mul_f32 v97, s39, v97
    v_exp_f32 v97, v97
    v_sub_f32 v98, v98, v5
    v_mul_f32 v98, s39, v98
    v_exp_f32 v98, v98
    v_sub_f32 v99, v99, v5
    v_mul_f32 v99, s39, v99
    v_exp_f32 v99, v99
    v_sub_f32 v100, v100, v5
    v_mul_f32 v100, s39, v100
    v_exp_f32 v100, v100
    v_sub_f32 v101, v101, v5
    v_mul_f32 v101, s39, v101
    v_exp_f32 v101, v101
    v_sub_f32 v102, v102, v5
    v_mul_f32 v102, s39, v102
    v_exp_f32 v102, v102
    v_sub_f32 v103, v103, v5
    v_mul_f32 v103, s39, v103
    v_exp_f32 v103, v103
    v_sub_f32 v104, v104, v5
    v_mul_f32 v104, s39, v104
    v_exp_f32 v104, v104
    v_sub_f32 v105, v105, v5
    v_mul_f32 v105, s39, v105
    v_exp_f32 v105, v105
    v_sub_f32 v106, v106, v5
    v_mul_f32 v106, s39, v106
    v_exp_f32 v106, v106
    v_sub_f32 v107, v107, v5
    v_mul_f32 v107, s39, v107
    v_exp_f32 v107, v107
    v_sub_f32 v108, v108, v5
    v_mul_f32 v108, s39, v108
    v_exp_f32 v108, v108
    v_sub_f32 v109, v109, v5
    v_mul_f32 v109, s39, v109
    v_exp_f32 v109, v109
    v_sub_f32 v110, v110, v5
    v_mul_f32 v110, s39, v110
    v_exp_f32 v110, v110
    v_sub_f32 v111, v111, v5
    v_mul_f32 v111, s39, v111
    v_exp_f32 v111, v111
    s_nop 0
    v_add_f32 v5, v96, v97
    v_add_f32 v5, v5, v98
    v_add_f32 v5, v5, v99
    v_add_f32 v5, v5, v100
    v_add_f32 v5, v5, v101
    v_add_f32 v5, v5, v102
    v_add_f32 v5, v5, v103
    v_add_f32 v5, v5, v104
    v_add_f32 v5, v5, v105
    v_add_f32 v5, v5, v106
    v_add_f32 v5, v5, v107
    v_add_f32 v5, v5, v108
    v_add_f32 v5, v5, v109
    v_add_f32 v5, v5, v110
    v_add_f32 v5, v5, v111
    v_mov_b32 v6, v5
    s_nop 1
    v_permlane32_swap_b32 v5, v6
    v_add_f32 v5, v5, v6
    v_rcp_f32 v5, v5
    s_nop 0
    v_mul_f32 v96, v96, v5
    v_mul_f32 v97, v97, v5
    v_mul_f32 v98, v98, v5
    v_mul_f32 v99, v99, v5
    v_mul_f32 v100, v100, v5
    v_mul_f32 v101, v101, v5
    v_mul_f32 v102, v102, v5
    v_mul_f32 v103, v103, v5
    v_mul_f32 v104, v104, v5
    v_mul_f32 v105, v105, v5
    v_mul_f32 v106, v106, v5
    v_mul_f32 v107, v107, v5
    v_mul_f32 v108, v108, v5
    v_mul_f32 v109, v109, v5
    v_mul_f32 v110, v110, v5
    v_mul_f32 v111, v111, v5
    v_cvt_pk_bf16_f32 v32, v96, v97
    v_cvt_pk_bf16_f32 v33, v98, v99
    v_cvt_pk_bf16_f32 v34, v100, v101
    v_cvt_pk_bf16_f32 v35, v102, v103
    v_cvt_pk_bf16_f32 v36, v104, v105
    v_cvt_pk_bf16_f32 v37, v106, v107
    v_cvt_pk_bf16_f32 v38, v108, v109
    v_cvt_pk_bf16_f32 v39, v110, v111
    v_lshrrev_b32 v2, 4, v1
    v_and_b32 v3, 15, v1
    v_lshrrev_b32 v4, 1, v2
    v_lshlrev_b32 v4, 2, v4
    v_lshrrev_b32 v5, 2, v3
    v_add_u32 v4, v4, v5
    v_and_b32 v6, 1, v2
    v_lshlrev_b32 v6, 1, v6
    v_bfe_u32 v7, v3, 1, 1
    v_add_u32 v6, v6, v7
    s_lshl_b32 s38, s37, 3
    v_add_u32 v6, s38, v6
    v_lshlrev_b32 v5, 2, v5
    v_xor_b32 v6, v6, v5
    v_lshlrev_b32 v6, 4, v6
    v_and_b32 v7, 1, v3
    v_lshl_add_u32 v6, v7, 3, v6
    v_lshl_add_u32 v6, v4, 8, v6
    s_lshl_b32 s38, s36, 14
    s_add_u32 s38, s38, 106496
    v_add_u32 v6, s38, v6
    v_xor_b32 v7, 64, v6
    ds_read_b64_tr_b16 v[64:65], v6 offset:0
    ds_read_b64_tr_b16 v[66:67], v6 offset:2048
    ds_read_b64_tr_b16 v[68:69], v6 offset:4096
    ds_read_b64_tr_b16 v[70:71], v6 offset:6144
    ds_read_b64_tr_b16 v[72:73], v7 offset:0
    ds_read_b64_tr_b16 v[74:75], v7 offset:2048
    ds_read_b64_tr_b16 v[76:77], v7 offset:4096
    ds_read_b64_tr_b16 v[78:79], v7 offset:6144
    v_mov_b32 v96, 0
    v_mov_b32 v97, 0
    v_mov_b32 v98, 0
    v_mov_b32 v99, 0
    v_mov_b32 v100, 0
    v_mov_b32 v101, 0
    v_mov_b32 v102, 0
    v_mov_b32 v103, 0
    v_mov_b32 v104, 0
    v_mov_b32 v105, 0
    v_mov_b32 v106, 0
    v_mov_b32 v107, 0
    v_mov_b32 v108, 0
    v_mov_b32 v109, 0
    v_mov_b32 v110, 0
    v_mov_b32 v111, 0
    v_mov_b32 v112, 0
    v_mov_b32 v113, 0
    v_mov_b32 v114, 0
    v_mov_b32 v115, 0
    v_mov_b32 v116, 0
    v_mov_b32 v117, 0
    v_mov_b32 v118, 0
    v_mov_b32 v119, 0
    v_mov_b32 v120, 0
    v_mov_b32 v121, 0
    v_mov_b32 v122, 0
    v_mov_b32 v123, 0
    v_mov_b32 v124, 0
    v_mov_b32 v125, 0
    v_mov_b32 v126, 0
    v_mov_b32 v127, 0
    s_waitcnt lgkmcnt(0)
    v_mfma_f32_32x32x16_bf16 v[96:111], v[64:67], v[32:35], v[96:111]
    v_mfma_f32_32x32x16_bf16 v[96:111], v[68:71], v[36:39], v[96:111]
    v_mfma_f32_32x32x16_bf16 v[112:127], v[72:75], v[32:35], v[112:127]
    v_mfma_f32_32x32x16_bf16 v[112:127], v[76:79], v[36:39], v[112:127]
    v_and_b32 v2, 31, v1
    v_lshrrev_b32 v3, 5, v1
    s_lshl_b32 s38, s4, 6
    s_lshl_b32 s39, s36, 5
    s_add_u32 s38, s38, s39
    v_add_u32 v2, s38, v2
    v_lshlrev_b32 v2, 13, v2
    v_lshl_add_u32 v2, v3, 3, v2
    s_lshl_b32 s38, s3, 8
    s_lshl_b32 s39, s37, 7
    s_add_u32 s38, s38, s39
    v_add_u32 v2, s38, v2
    s_nop 7
    s_nop 3
    v_cvt_pk_bf16_f32 v96, v96, v97
    v_cvt_pk_bf16_f32 v97, v98, v99
    buffer_store_dwordx2 v[96:97], v2, s[24:27], 0 offen offset:0
    v_cvt_pk_bf16_f32 v100, v100, v101
    v_cvt_pk_bf16_f32 v101, v102, v103
    buffer_store_dwordx2 v[100:101], v2, s[24:27], 0 offen offset:16
    v_cvt_pk_bf16_f32 v104, v104, v105
    v_cvt_pk_bf16_f32 v105, v106, v107
    buffer_store_dwordx2 v[104:105], v2, s[24:27], 0 offen offset:32
    v_cvt_pk_bf16_f32 v108, v108, v109
    v_cvt_pk_bf16_f32 v109, v110, v111
    buffer_store_dwordx2 v[108:109], v2, s[24:27], 0 offen offset:48
    v_cvt_pk_bf16_f32 v112, v112, v113
    v_cvt_pk_bf16_f32 v113, v114, v115
    buffer_store_dwordx2 v[112:113], v2, s[24:27], 0 offen offset:64
    v_cvt_pk_bf16_f32 v116, v116, v117
    v_cvt_pk_bf16_f32 v117, v118, v119
    buffer_store_dwordx2 v[116:117], v2, s[24:27], 0 offen offset:80
    v_cvt_pk_bf16_f32 v120, v120, v121
    v_cvt_pk_bf16_f32 v121, v122, v123
    buffer_store_dwordx2 v[120:121], v2, s[24:27], 0 offen offset:96
    v_cvt_pk_bf16_f32 v124, v124, v125
    v_cvt_pk_bf16_f32 v125, v126, v127
    buffer_store_dwordx2 v[124:125], v2, s[24:27], 0 offen offset:112
L1_done:
    s_endpgm
.globl mha_oproj_kernel
.p2align 8
.type mha_oproj_kernel,@function
mha_oproj_kernel:
    s_cmp_ge_u32 s2, 256
    s_cbranch_scc1 L2_done
    s_load_dwordx2 s[44:45], s[0:1], 32
    s_load_dwordx2 s[52:53], s[0:1], 56
    s_bfe_u32 s5, s2, 0x20001
    s_and_b32 s3, s2, 1
    s_lshl_b32 s3, s3, 2
    s_bfe_u32 s4, s2, 0x20003
    s_add_u32 s3, s3, s4
    s_lshr_b32 s4, s2, 5
    s_waitcnt lgkmcnt(0)
    s_mov_b32 s8, s52
    s_mov_b32 s9, s53
    s_mov_b32 s10, 4194304
    s_mov_b32 s11, 0x00020000
    s_mov_b32 s12, s44
    s_mov_b32 s13, s45
    s_mov_b32 s14, 8388608
    s_mov_b32 s15, 0x00020000
    s_add_u32 s52, s52, 0x400000
    s_addc_u32 s53, s53, 0
    s_mov_b32 s24, s52
    s_mov_b32 s25, s53
    s_mov_b32 s26, 8388608
    s_mov_b32 s27, 0x00020000
    s_lshl_b32 s30, s4, 19
    s_lshl_b32 s38, s5, 11
    s_add_u32 s30, s30, s38
    s_lshl_b32 s31, s5, 21
    s_lshl_b32 s38, s3, 8
    s_add_u32 s31, s31, s38
    v_and_b32 v1, 63, v0
    v_lshrrev_b32 v2, 6, v0
    s_nop 0
    v_readfirstlane_b32 s28, v2
    s_nop 3
    s_lshl_b32 s32, s28, 11
    s_lshl_b32 s33, s28, 12
    v_lshrrev_b32 v2, 3, v1
    v_lshrrev_b32 v3, 4, v1
    v_and_b32 v4, 7, v1
    v_xor_b32 v4, v4, v3
    s_lshl_b32 s34, s28, 4
    v_add_u32 v2, s34, v2
    s_mov_b32 s35, 8192
    v_mul_lo_u32 v2, v2, s35
    v_lshl_add_u32 v10, v4, 4, v2
    v_add_u32 v10, s30, v10
    v_xor_b32 v11, 64, v10
    v_add_u32 v11, 65536, v11
    v_and_b32 v4, 15, v1
    v_lshlrev_b32 v5, 2, v3
    v_xor_b32 v4, v4, v5
    s_lshl_b32 s34, s28, 4
    v_add_u32 v5, s34, v3
    s_mov_b32 s35, 2048
    v_mul_lo_u32 v5, v5, s35
    v_lshl_add_u32 v12, v4, 4, v5
    v_add_u32 v12, s31, v12
    s_and_b32 s36, s28, 1
    s_lshr_b32 s37, s28, 1
    v_and_b32 v2, 31, v1
    v_lshrrev_b32 v3, 5, v1
    v_lshrrev_b32 v4, 1, v2
    v_and_b32 v4, 7, v4
    v_xor_b32 v4, v4, v3
    s_lshl_b32 s38, s36, 12
    v_lshlrev_b32 v5, 7, v2
    v_add_u32 v5, s38, v5
    v_xor_b32 v6, 0, v4
    v_lshl_add_u32 v16, v6, 4, v5
    v_add_u32 v20, 49152, v16
    v_xor_b32 v6, 2, v4
    v_lshl_add_u32 v17, v6, 4, v5
    v_add_u32 v21, 49152, v17
    v_xor_b32 v6, 4, v4
    v_lshl_add_u32 v18, v6, 4, v5
    v_add_u32 v22, 49152, v18
    v_xor_b32 v6, 6, v4
    v_lshl_add_u32 v19, v6, 4, v5
    v_add_u32 v23, 49152, v19
    v_lshrrev_b32 v2, 4, v1
    v_and_b32 v3, 15, v1
    v_lshrrev_b32 v4, 1, v2
    v_lshlrev_b32 v4, 3, v4
    v_lshrrev_b32 v5, 2, v3
    v_add_u32 v4, v4, v5
    v_and_b32 v6, 1, v2
    v_lshlrev_b32 v6, 1, v6
    v_bfe_u32 v7, v3, 1, 1
    v_add_u32 v6, v6, v7
    s_lshl_b32 s38, s37, 3
    v_add_u32 v6, s38, v6
    v_lshlrev_b32 v5, 2, v5
    v_xor_b32 v6, v6, v5
    v_lshlrev_b32 v6, 4, v6
    v_and_b32 v7, 1, v3
    v_lshl_add_u32 v6, v7, 3, v6
    v_lshl_add_u32 v6, v4, 8, v6
    v_add_u32 v24, 8192, v6
    v_xor_b32 v25, 64, v24
    v_add_u32 v26, 49152, v24
    v_add_u32 v27, 49152, v25
    v_mov_b32 v64, 0
    v_mov_b32 v65, 0
    v_mov_b32 v66, 0
    v_mov_b32 v67, 0
    v_mov_b32 v68, 0
    v_mov_b32 v69, 0
    v_mov_b32 v70, 0
    v_mov_b32 v71, 0
    v_mov_b32 v72, 0
    v_mov_b32 v73, 0
    v_mov_b32 v74, 0
    v_mov_b32 v75, 0
    v_mov_b32 v76, 0
    v_mov_b32 v77, 0
    v_mov_b32 v78, 0
    v_mov_b32 v79, 0
    v_mov_b32 v80, 0
    v_mov_b32 v81, 0
    v_mov_b32 v82, 0
    v_mov_b32 v83, 0
    v_mov_b32 v84, 0
    v_mov_b32 v85, 0
    v_mov_b32 v86, 0
    v_mov_b32 v87, 0
    v_mov_b32 v88, 0
    v_mov_b32 v89, 0
    v_mov_b32 v90, 0
    v_mov_b32 v91, 0
    v_mov_b32 v92, 0
    v_mov_b32 v93, 0
    v_mov_b32 v94, 0
    v_mov_b32 v95, 0
    s_add_u32 m0, s32, 0
    s_mov_b32 s40, 0
    buffer_load_dwordx4 v10, s[8:11], s40 offen lds
    s_add_u32 m0, s32, 1024
    s_mov_b32 s40, 0
    buffer_load_dwordx4 v11, s[8:11], s40 offen lds
    s_add_u32 m0, s33, 8192
    s_mov_b32 s40, 0
    buffer_load_dwordx4 v12, s[12:15], s40 offen lds
    s_add_u32 m0, s33, 9216
    s_mov_b32 s40, 8192
    buffer_load_dwordx4 v12, s[12:15], s40 offen lds
    s_add_u32 m0, s33, 10240
    s_mov_b32 s40, 16384
    buffer_load_dwordx4 v12, s[12:15], s40 offen lds
    s_add_u32 m0, s33, 11264
    s_mov_b32 s40, 24576
    buffer_load_dwordx4 v12, s[12:15], s40 offen lds
    s_add_u32 m0, s32, 24576
    s_mov_b32 s40, 128
    buffer_load_dwordx4 v10, s[8:11], s40 offen lds
    s_add_u32 m0, s32, 25600
    s_mov_b32 s40, 128
    buffer_load_dwordx4 v11, s[8:11], s40 offen lds
    s_add_u32 m0, s33, 32768
    s_mov_b32 s40, 131072
    buffer_load_dwordx4 v12, s[12:15], s40 offen lds
    s_add_u32 m0, s33, 33792
    s_mov_b32 s40, 139264
    buffer_load_dwordx4 v12, s[12:15], s40 offen lds
    s_add_u32 m0, s33, 34816
    s_mov_b32 s40, 147456
    buffer_load_dwordx4 v12, s[12:15], s40 offen lds
    s_add_u32 m0, s33, 35840
    s_mov_b32 s40, 155648
    buffer_load_dwordx4 v12, s[12:15], s40 offen lds
    s_add_u32 m0, s32, 49152
    s_mov_b32 s40, 256
    buffer_load_dwordx4 v10, s[8:11], s40 offen lds
    s_add_u32 m0, s32, 50176
    s_mov_b32 s40, 256
    buffer_load_dwordx4 v11, s[8:11], s40 offen lds
    s_add_u32 m0, s33, 57344
    s_mov_b32 s40, 262144
    buffer_load_dwordx4 v12, s[12:15], s40 offen lds
    s_add_u32 m0, s33, 58368
    s_mov_b32 s40, 270336
    buffer_load_dwordx4 v12, s[12:15], s40 offen lds
    s_add_u32 m0, s33, 59392
    s_mov_b32 s40, 278528
    buffer_load_dwordx4 v12, s[12:15], s40 offen lds
    s_add_u32 m0, s33, 60416
    s_mov_b32 s40, 286720
    buffer_load_dwordx4 v12, s[12:15], s40 offen lds
    s_waitcnt vmcnt(12)
    s_barrier
    s_add_u32 m0, s32, 73728
    s_mov_b32 s40, 384
    buffer_load_dwordx4 v10, s[8:11], s40 offen lds
    s_add_u32 m0, s32, 74752
    s_mov_b32 s40, 384
    buffer_load_dwordx4 v11, s[8:11], s40 offen lds
    s_add_u32 m0, s33, 81920
    s_mov_b32 s40, 393216
    buffer_load_dwordx4 v12, s[12:15], s40 offen lds
    s_add_u32 m0, s33, 82944
    s_mov_b32 s40, 401408
    buffer_load_dwordx4 v12, s[12:15], s40 offen lds
    s_add_u32 m0, s33, 83968
    s_mov_b32 s40, 409600
    buffer_load_dwordx4 v12, s[12:15], s40 offen lds
    s_add_u32 m0, s33, 84992
    s_mov_b32 s40, 417792
    buffer_load_dwordx4 v12, s[12:15], s40 offen lds
    ds_read_b128 v[32:35], v16 offset:0
    ds_read_b64_tr_b16 v[36:37], v24 offset:0
    ds_read_b64_tr_b16 v[38:39], v24 offset:1024
    ds_read_b64_tr_b16 v[40:41], v25 offset:0
    ds_read_b64_tr_b16 v[42:43], v25 offset:1024
    ds_read_b128 v[44:47], v17 offset:0
    ds_read_b64_tr_b16 v[48:49], v24 offset:4096
    ds_read_b64_tr_b16 v[50:51], v24 offset:5120
    ds_read_b64_tr_b16 v[52:53], v25 offset:4096
    ds_read_b64_tr_b16 v[54:55], v25 offset:5120
    s_waitcnt lgkmcnt(5)
    v_mfma_f32_32x32x16_bf16 v[64:79], v[36:39], v[32:35], v[64:79]
    v_mfma_f32_32x32x16_bf16 v[80:95], v[40:43], v[32:35], v[80:95]
    ds_read_b128 v[32:35], v18 offset:0
    ds_read_b64_tr_b16 v[36:37], v24 offset:8192
    ds_read_b64_tr_b16 v[38:39], v24 offset:9216
    ds_read_b64_tr_b16 v[40:41], v25 offset:8192
    ds_read_b64_tr_b16 v[42:43], v25 offset:9216
    s_waitcnt lgkmcnt(5)
    v_mfma_f32_32x32x16_bf16 v[64:79], v[48:51], v[44:47], v[64:79]
    v_mfma_f32_32x32x16_bf16 v[80:95], v[52:55], v[44:47], v[80:95]
    ds_read_b128 v[44:47], v19 offset:0
    ds_read_b64_tr_b16 v[48:49], v24 offset:12288
    ds_read_b64_tr_b16 v[50:51], v24 offset:13312
    ds_read_b64_tr_b16 v[52:53], v25 offset:12288
    ds_read_b64_tr_b16 v[54:55], v25 offset:13312
    s_waitcnt lgkmcnt(5)
    v_mfma_f32_32x32x16_bf16 v[64:79], v[36:39], v[32:35], v[64:79]
    v_mfma_f32_32x32x16_bf16 v[80:95], v[40:43], v[32:35], v[80:95]
    s_waitcnt lgkmcnt(0)
    v_mfma_f32_32x32x16_bf16 v[64:79], v[48:51], v[44:47], v[64:79]
    v_mfma_f32_32x32x16_bf16 v[80:95], v[52:55], v[44:47], v[80:95]
    s_waitcnt vmcnt(12)
    s_barrier
    s_add_u32 m0, s32, 0
    s_mov_b32 s40, 512
    buffer_load_dwordx4 v10, s[8:11], s40 offen lds
    s_add_u32 m0, s32, 1024
    s_mov_b32 s40, 512
    buffer_load_dwordx4 v11, s[8:11], s40 offen lds
    s_add_u32 m0, s33, 8192
    s_mov_b32 s40, 524288
    buffer_load_dwordx4 v12, s[12:15], s40 offen lds
    s_add_u32 m0, s33, 9216
    s_mov_b32 s40, 532480
    buffer_load_dwordx4 v12, s[12:15], s40 offen lds
    s_add_u32 m0, s33, 10240
    s_mov_b32 s40, 540672
    buffer_load_dwordx4 v12, s[12:15], s40 offen lds
    s_add_u32 m0, s33, 11264
    s_mov_b32 s40, 548864
    buffer_load_dwordx4 v12, s[12:15], s40 offen lds
    ds_read_b128 v[32:35], v16 offset:24576
    ds_read_b64_tr_b16 v[36:37], v24 offset:24576
    ds_read_b64_tr_b16 v[38:39], v24 offset:25600
    ds_read_b64_tr_b16 v[40:41], v25 offset:24576
    ds_read_b64_tr_b16 v[42:43], v25 offset:25600
    ds_read_b128 v[44:47], v17 offset:24576
    ds_read_b64_tr_b16 v[48:49], v24 offset:28672
    ds_read_b64_tr_b16 v[50:51], v24 offset:29696
    ds_read_b64_tr_b16 v[52:53], v25 offset:28672
    ds_read_b64_tr_b16 v[54:55], v25 offset:29696
    s_waitcnt lgkmcnt(5)
    v_mfma_f32_32x32x16_bf16 v[64:79], v[36:39], v[32:35], v[64:79]
    v_mfma_f32_32x32x16_bf16 v[80:95], v[40:43], v[32:35], v[80:95]
    ds_read_b128 v[32:35], v18 offset:24576
    ds_read_b64_tr_b16 v[36:37], v24 offset:32768
    ds_read_b64_tr_b16 v[38:39], v24 offset:33792
    ds_read_b64_tr_b16 v[40:41], v25 offset:32768
    ds_read_b64_tr_b16 v[42:43], v25 offset:33792
    s_waitcnt lgkmcnt(5)
    v_mfma_f32_32x32x16_bf16 v[64:79], v[48:51], v[44:47], v[64:79]
    v_mfma_f32_32x32x16_bf16 v[80:95], v[52:55], v[44:47], v[80:95]
    ds_read_b128 v[44:47], v19 offset:24576
    ds_read_b64_tr_b16 v[48:49], v24 offset:36864
    ds_read_b64_tr_b16 v[50:51], v24 offset:37888
    ds_read_b64_tr_b16 v[52:53], v25 offset:36864
    ds_read_b64_tr_b16 v[54:55], v25 offset:37888
    s_waitcnt lgkmcnt(5)
    v_mfma_f32_32x32x16_bf16 v[64:79], v[36:39], v[32:35], v[64:79]
    v_mfma_f32_32x32x16_bf16 v[80:95], v[40:43], v[32:35], v[80:95]
    s_waitcnt lgkmcnt(0)
    v_mfma_f32_32x32x16_bf16 v[64:79], v[48:51], v[44:47], v[64:79]
    v_mfma_f32_32x32x16_bf16 v[80:95], v[52:55], v[44:47], v[80:95]
    s_waitcnt vmcnt(12)
    s_barrier
    s_add_u32 m0, s32, 24576
    s_mov_b32 s40, 640
    buffer_load_dwordx4 v10, s[8:11], s40 offen lds
    s_add_u32 m0, s32, 25600
    s_mov_b32 s40, 640
    buffer_load_dwordx4 v11, s[8:11], s40 offen lds
    s_add_u32 m0, s33, 32768
    s_mov_b32 s40, 655360
    buffer_load_dwordx4 v12, s[12:15], s40 offen lds
    s_add_u32 m0, s33, 33792
    s_mov_b32 s40, 663552
    buffer_load_dwordx4 v12, s[12:15], s40 offen lds
    s_add_u32 m0, s33, 34816
    s_mov_b32 s40, 671744
    buffer_load_dwordx4 v12, s[12:15], s40 offen lds
    s_add_u32 m0, s33, 35840
    s_mov_b32 s40, 679936
    buffer_load_dwordx4 v12, s[12:15], s40 offen lds
    ds_read_b128 v[32:35], v20 offset:0
    ds_read_b64_tr_b16 v[36:37], v26 offset:0
    ds_read_b64_tr_b16 v[38:39], v26 offset:1024
    ds_read_b64_tr_b16 v[40:41], v27 offset:0
    ds_read_b64_tr_b16 v[42:43], v27 offset:1024
    ds_read_b128 v[44:47], v21 offset:0
    ds_read_b64_tr_b16 v[48:49], v26 offset:4096
    ds_read_b64_tr_b16 v[50:51], v26 offset:5120
    ds_read_b64_tr_b16 v[52:53], v27 offset:4096
    ds_read_b64_tr_b16 v[54:55], v27 offset:5120
    s_waitcnt lgkmcnt(5)
    v_mfma_f32_32x32x16_bf16 v[64:79], v[36:39], v[32:35], v[64:79]
    v_mfma_f32_32x32x16_bf16 v[80:95], v[40:43], v[32:35], v[80:95]
    ds_read_b128 v[32:35], v22 offset:0
    ds_read_b64_tr_b16 v[36:37], v26 offset:8192
    ds_read_b64_tr_b16 v[38:39], v26 offset:9216
    ds_read_b64_tr_b16 v[40:41], v27 offset:8192
    ds_read_b64_tr_b16 v[42:43], v27 offset:9216
    s_waitcnt lgkmcnt(5)
    v_mfma_f32_32x32x16_bf16 v[64:79], v[48:51], v[44:47], v[64:79]
    v_mfma_f32_32x32x16_bf16 v[80:95], v[52:55], v[44:47], v[80:95]
    ds_read_b128 v[44:47], v23 offset:0
    ds_read_b64_tr_b16 v[48:49], v26 offset:12288
    ds_read_b64_tr_b16 v[50:51], v26 offset:13312
    ds_read_b64_tr_b16 v[52:53], v27 offset:12288
    ds_read_b64_tr_b16 v[54:55], v27 offset:13312
    s_waitcnt lgkmcnt(5)
    v_mfma_f32_32x32x16_bf16 v[64:79], v[36:39], v[32:35], v[64:79]
    v_mfma_f32_32x32x16_bf16 v[80:95], v[40:43], v[32:35], v[80:95]
    s_waitcnt lgkmcnt(0)
    v_mfma_f32_32x32x16_bf16 v[64:79], v[48:51], v[44:47], v[64:79]
    v_mfma_f32_32x32x16_bf16 v[80:95], v[52:55], v[44:47], v[80:95]
    s_waitcnt vmcnt(12)
    s_barrier
    s_add_u32 m0, s32, 49152
    s_mov_b32 s40, 768
    buffer_load_dwordx4 v10, s[8:11], s40 offen lds
    s_add_u32 m0, s32, 50176
    s_mov_b32 s40, 768
    buffer_load_dwordx4 v11, s[8:11], s40 offen lds
    s_add_u32 m0, s33, 57344
    s_mov_b32 s40, 786432
    buffer_load_dwordx4 v12, s[12:15], s40 offen lds
    s_add_u32 m0, s33, 58368
    s_mov_b32 s40, 794624
    buffer_load_dwordx4 v12, s[12:15], s40 offen lds
    s_add_u32 m0, s33, 59392
    s_mov_b32 s40, 802816
    buffer_load_dwordx4 v12, s[12:15], s40 offen lds
    s_add_u32 m0, s33, 60416
    s_mov_b32 s40, 811008
    buffer_load_dwordx4 v12, s[12:15], s40 offen lds
    ds_read_b128 v[32:35], v20 offset:24576
    ds_read_b64_tr_b16 v[36:37], v26 offset:24576
    ds_read_b64_tr_b16 v[38:39], v26 offset:25600
    ds_read_b64_tr_b16 v[40:41], v27 offset:24576
    ds_read_b64_tr_b16 v[42:43], v27 offset:25600
    ds_read_b128 v[44:47], v21 offset:24576
    ds_read_b64_tr_b16 v[48:49], v26 offset:28672
    ds_read_b64_tr_b16 v[50:51], v26 offset:29696
    ds_read_b64_tr_b16 v[52:53], v27 offset:28672
    ds_read_b64_tr_b16 v[54:55], v27 offset:29696
    s_waitcnt lgkmcnt(5)
    v_mfma_f32_32x32x16_bf16 v[64:79], v[36:39], v[32:35], v[64:79]
    v_mfma_f32_32x32x16_bf16 v[80:95], v[40:43], v[32:35], v[80:95]
    ds_read_b128 v[32:35], v22 offset:24576
    ds_read_b64_tr_b16 v[36:37], v26 offset:32768
    ds_read_b64_tr_b16 v[38:39], v26 offset:33792
    ds_read_b64_tr_b16 v[40:41], v27 offset:32768
    ds_read_b64_tr_b16 v[42:43], v27 offset:33792
    s_waitcnt lgkmcnt(5)
    v_mfma_f32_32x32x16_bf16 v[64:79], v[48:51], v[44:47], v[64:79]
    v_mfma_f32_32x32x16_bf16 v[80:95], v[52:55], v[44:47], v[80:95]
    ds_read_b128 v[44:47], v23 offset:24576
    ds_read_b64_tr_b16 v[48:49], v26 offset:36864
    ds_read_b64_tr_b16 v[50:51], v26 offset:37888
    ds_read_b64_tr_b16 v[52:53], v27 offset:36864
    ds_read_b64_tr_b16 v[54:55], v27 offset:37888
    s_waitcnt lgkmcnt(5)
    v_mfma_f32_32x32x16_bf16 v[64:79], v[36:39], v[32:35], v[64:79]
    v_mfma_f32_32x32x16_bf16 v[80:95], v[40:43], v[32:35], v[80:95]
    s_waitcnt lgkmcnt(0)
    v_mfma_f32_32x32x16_bf16 v[64:79], v[48:51], v[44:47], v[64:79]
    v_mfma_f32_32x32x16_bf16 v[80:95], v[52:55], v[44:47], v[80:95]
    s_waitcnt vmcnt(12)
    s_barrier
    s_add_u32 m0, s32, 73728
    s_mov_b32 s40, 896
    buffer_load_dwordx4 v10, s[8:11], s40 offen lds
    s_add_u32 m0, s32, 74752
    s_mov_b32 s40, 896
    buffer_load_dwordx4 v11, s[8:11], s40 offen lds
    s_add_u32 m0, s33, 81920
    s_mov_b32 s40, 917504
    buffer_load_dwordx4 v12, s[12:15], s40 offen lds
    s_add_u32 m0, s33, 82944
    s_mov_b32 s40, 925696
    buffer_load_dwordx4 v12, s[12:15], s40 offen lds
    s_add_u32 m0, s33, 83968
    s_mov_b32 s40, 933888
    buffer_load_dwordx4 v12, s[12:15], s40 offen lds
    s_add_u32 m0, s33, 84992
    s_mov_b32 s40, 942080
    buffer_load_dwordx4 v12, s[12:15], s40 offen lds
    ds_read_b128 v[32:35], v16 offset:0
    ds_read_b64_tr_b16 v[36:37], v24 offset:0
    ds_read_b64_tr_b16 v[38:39], v24 offset:1024
    ds_read_b64_tr_b16 v[40:41], v25 offset:0
    ds_read_b64_tr_b16 v[42:43], v25 offset:1024
    ds_read_b128 v[44:47], v17 offset:0
    ds_read_b64_tr_b16 v[48:49], v24 offset:4096
    ds_read_b64_tr_b16 v[50:51], v24 offset:5120
    ds_read_b64_tr_b16 v[52:53], v25 offset:4096
    ds_read_b64_tr_b16 v[54:55], v25 offset:5120
    s_waitcnt lgkmcnt(5)
    v_mfma_f32_32x32x16_bf16 v[64:79], v[36:39], v[32:35], v[64:79]
    v_mfma_f32_32x32x16_bf16 v[80:95], v[40:43], v[32:35], v[80:95]
    ds_read_b128 v[32:35], v18 offset:0
    ds_read_b64_tr_b16 v[36:37], v24 offset:8192
    ds_read_b64_tr_b16 v[38:39], v24 offset:9216
    ds_read_b64_tr_b16 v[40:41], v25 offset:8192
    ds_read_b64_tr_b16 v[42:43], v25 offset:9216
    s_waitcnt lgkmcnt(5)
    v_mfma_f32_32x32x16_bf16 v[64:79], v[48:51], v[44:47], v[64:79]
    v_mfma_f32_32x32x16_bf16 v[80:95], v[52:55], v[44:47], v[80:95]
    ds_read_b128 v[44:47], v19 offset:0
    ds_read_b64_tr_b16 v[48:49], v24 offset:12288
    ds_read_b64_tr_b16 v[50:51], v24 offset:13312
    ds_read_b64_tr_b16 v[52:53], v25 offset:12288
    ds_read_b64_tr_b16 v[54:55], v25 offset:13312
    s_waitcnt lgkmcnt(5)
    v_mfma_f32_32x32x16_bf16 v[64:79], v[36:39], v[32:35], v[64:79]
    v_mfma_f32_32x32x16_bf16 v[80:95], v[40:43], v[32:35], v[80:95]
    s_waitcnt lgkmcnt(0)
    v_mfma_f32_32x32x16_bf16 v[64:79], v[48:51], v[44:47], v[64:79]
    v_mfma_f32_32x32x16_bf16 v[80:95], v[52:55], v[44:47], v[80:95]
    s_waitcnt vmcnt(12)
    s_barrier
    s_add_u32 m0, s32, 0
    s_mov_b32 s40, 1024
    buffer_load_dwordx4 v10, s[8:11], s40 offen lds
    s_add_u32 m0, s32, 1024
    s_mov_b32 s40, 1024
    buffer_load_dwordx4 v11, s[8:11], s40 offen lds
    s_add_u32 m0, s33, 8192
    s_mov_b32 s40, 1048576
    buffer_load_dwordx4 v12, s[12:15], s40 offen lds
    s_add_u32 m0, s33, 9216
    s_mov_b32 s40, 1056768
    buffer_load_dwordx4 v12, s[12:15], s40 offen lds
    s_add_u32 m0, s33, 10240
    s_mov_b32 s40, 1064960
    buffer_load_dwordx4 v12, s[12:15], s40 offen lds
    s_add_u32 m0, s33, 11264
    s_mov_b32 s40, 1073152
    buffer_load_dwordx4 v12, s[12:15], s40 offen lds
    ds_read_b128 v[32:35], v16 offset:24576
    ds_read_b64_tr_b16 v[36:37], v24 offset:24576
    ds_read_b64_tr_b16 v[38:39], v24 offset:25600
    ds_read_b64_tr_b16 v[40:41], v25 offset:24576
    ds_read_b64_tr_b16 v[42:43], v25 offset:25600
    ds_read_b128 v[44:47], v17 offset:24576
    ds_read_b64_tr_b16 v[48:49], v24 offset:28672
    ds_read_b64_tr_b16 v[50:51], v24 offset:29696
    ds_read_b64_tr_b16 v[52:53], v25 offset:28672
    ds_read_b64_tr_b16 v[54:55], v25 offset:29696
    s_waitcnt lgkmcnt(5)
    v_mfma_f32_32x32x16_bf16 v[64:79], v[36:39], v[32:35], v[64:79]
    v_mfma_f32_32x32x16_bf16 v[80:95], v[40:43], v[32:35], v[80:95]
    ds_read_b128 v[32:35], v18 offset:24576
    ds_read_b64_tr_b16 v[36:37], v24 offset:32768
    ds_read_b64_tr_b16 v[38:39], v24 offset:33792
    ds_read_b64_tr_b16 v[40:41], v25 offset:32768
    ds_read_b64_tr_b16 v[42:43], v25 offset:33792
    s_waitcnt lgkmcnt(5)
    v_mfma_f32_32x32x16_bf16 v[64:79], v[48:51], v[44:47], v[64:79]
    v_mfma_f32_32x32x16_bf16 v[80:95], v[52:55], v[44:47], v[80:95]
    ds_read_b128 v[44:47], v19 offset:24576
    ds_read_b64_tr_b16 v[48:49], v24 offset:36864
    ds_read_b64_tr_b16 v[50:51], v24 offset:37888
    ds_read_b64_tr_b16 v[52:53], v25 offset:36864
    ds_read_b64_tr_b16 v[54:55], v25 offset:37888
    s_waitcnt lgkmcnt(5)
    v_mfma_f32_32x32x16_bf16 v[64:79], v[36:39], v[32:35], v[64:79]
    v_mfma_f32_32x32x16_bf16 v[80:95], v[40:43], v[32:35], v[80:95]
    s_waitcnt lgkmcnt(0)
    v_mfma_f32_32x32x16_bf16 v[64:79], v[48:51], v[44:47], v[64:79]
    v_mfma_f32_32x32x16_bf16 v[80:95], v[52:55], v[44:47], v[80:95]
    s_waitcnt vmcnt(12)
    s_barrier
    s_add_u32 m0, s32, 24576
    s_mov_b32 s40, 1152
    buffer_load_dwordx4 v10, s[8:11], s40 offen lds
    s_add_u32 m0, s32, 25600
    s_mov_b32 s40, 1152
    buffer_load_dwordx4 v11, s[8:11], s40 offen lds
    s_add_u32 m0, s33, 32768
    s_mov_b32 s40, 1179648
    buffer_load_dwordx4 v12, s[12:15], s40 offen lds
    s_add_u32 m0, s33, 33792
    s_mov_b32 s40, 1187840
    buffer_load_dwordx4 v12, s[12:15], s40 offen lds
    s_add_u32 m0, s33, 34816
    s_mov_b32 s40, 1196032
    buffer_load_dwordx4 v12, s[12:15], s40 offen lds
    s_add_u32 m0, s33, 35840
    s_mov_b32 s40, 1204224
    buffer_load_dwordx4 v12, s[12:15], s40 offen lds
    ds_read_b128 v[32:35], v20 offset:0
    ds_read_b64_tr_b16 v[36:37], v26 offset:0
    ds_read_b64_tr_b16 v[38:39], v26 offset:1024
    ds_read_b64_tr_b16 v[40:41], v27 offset:0
    ds_read_b64_tr_b16 v[42:43], v27 offset:1024
    ds_read_b128 v[44:47], v21 offset:0
    ds_read_b64_tr_b16 v[48:49], v26 offset:4096
    ds_read_b64_tr_b16 v[50:51], v26 offset:5120
    ds_read_b64_tr_b16 v[52:53], v27 offset:4096
    ds_read_b64_tr_b16 v[54:55], v27 offset:5120
    s_waitcnt lgkmcnt(5)
    v_mfma_f32_32x32x16_bf16 v[64:79], v[36:39], v[32:35], v[64:79]
    v_mfma_f32_32x32x16_bf16 v[80:95], v[40:43], v[32:35], v[80:95]
    ds_read_b128 v[32:35], v22 offset:0
    ds_read_b64_tr_b16 v[36:37], v26 offset:8192
    ds_read_b64_tr_b16 v[38:39], v26 offset:9216
    ds_read_b64_tr_b16 v[40:41], v27 offset:8192
    ds_read_b64_tr_b16 v[42:43], v27 offset:9216
    s_waitcnt lgkmcnt(5)
    v_mfma_f32_32x32x16_bf16 v[64:79], v[48:51], v[44:47], v[64:79]
    v_mfma_f32_32x32x16_bf16 v[80:95], v[52:55], v[44:47], v[80:95]
    ds_read_b128 v[44:47], v23 offset:0
    ds_read_b64_tr_b16 v[48:49], v26 offset:12288
    ds_read_b64_tr_b16 v[50:51], v26 offset:13312
    ds_read_b64_tr_b16 v[52:53], v27 offset:12288
    ds_read_b64_tr_b16 v[54:55], v27 offset:13312
    s_waitcnt lgkmcnt(5)
    v_mfma_f32_32x32x16_bf16 v[64:79], v[36:39], v[32:35], v[64:79]
    v_mfma_f32_32x32x16_bf16 v[80:95], v[40:43], v[32:35], v[80:95]
    s_waitcnt lgkmcnt(0)
    v_mfma_f32_32x32x16_bf16 v[64:79], v[48:51], v[44:47], v[64:79]
    v_mfma_f32_32x32x16_bf16 v[80:95], v[52:55], v[44:47], v[80:95]
    s_waitcnt vmcnt(12)
    s_barrier
    s_add_u32 m0, s32, 49152
    s_mov_b32 s40, 1280
    buffer_load_dwordx4 v10, s[8:11], s40 offen lds
    s_add_u32 m0, s32, 50176
    s_mov_b32 s40, 1280
    buffer_load_dwordx4 v11, s[8:11], s40 offen lds
    s_add_u32 m0, s33, 57344
    s_mov_b32 s40, 1310720
    buffer_load_dwordx4 v12, s[12:15], s40 offen lds
    s_add_u32 m0, s33, 58368
    s_mov_b32 s40, 1318912
    buffer_load_dwordx4 v12, s[12:15], s40 offen lds
    s_add_u32 m0, s33, 59392
    s_mov_b32 s40, 1327104
    buffer_load_dwordx4 v12, s[12:15], s40 offen lds
    s_add_u32 m0, s33, 60416
    s_mov_b32 s40, 1335296
    buffer_load_dwordx4 v12, s[12:15], s40 offen lds
    ds_read_b128 v[32:35], v20 offset:24576
    ds_read_b64_tr_b16 v[36:37], v26 offset:24576
    ds_read_b64_tr_b16 v[38:39], v26 offset:25600
    ds_read_b64_tr_b16 v[40:41], v27 offset:24576
    ds_read_b64_tr_b16 v[42:43], v27 offset:25600
    ds_read_b128 v[44:47], v21 offset:24576
    ds_read_b64_tr_b16 v[48:49], v26 offset:28672
    ds_read_b64_tr_b16 v[50:51], v26 offset:29696
    ds_read_b64_tr_b16 v[52:53], v27 offset:28672
    ds_read_b64_tr_b16 v[54:55], v27 offset:29696
    s_waitcnt lgkmcnt(5)
    v_mfma_f32_32x32x16_bf16 v[64:79], v[36:39], v[32:35], v[64:79]
    v_mfma_f32_32x32x16_bf16 v[80:95], v[40:43], v[32:35], v[80:95]
    ds_read_b128 v[32:35], v22 offset:24576
    ds_read_b64_tr_b16 v[36:37], v26 offset:32768
    ds_read_b64_tr_b16 v[38:39], v26 offset:33792
    ds_read_b64_tr_b16 v[40:41], v27 offset:32768
    ds_read_b64_tr_b16 v[42:43], v27 offset:33792
    s_waitcnt lgkmcnt(5)
    v_mfma_f32_32x32x16_bf16 v[64:79], v[48:51], v[44:47], v[64:79]
    v_mfma_f32_32x32x16_bf16 v[80:95], v[52:55], v[44:47], v[80:95]
    ds_read_b128 v[44:47], v23 offset:24576
    ds_read_b64_tr_b16 v[48:49], v26 offset:36864
    ds_read_b64_tr_b16 v[50:51], v26 offset:37888
    ds_read_b64_tr_b16 v[52:53], v27 offset:36864
    ds_read_b64_tr_b16 v[54:55], v27 offset:37888
    s_waitcnt lgkmcnt(5)
    v_mfma_f32_32x32x16_bf16 v[64:79], v[36:39], v[32:35], v[64:79]
    v_mfma_f32_32x32x16_bf16 v[80:95], v[40:43], v[32:35], v[80:95]
    s_waitcnt lgkmcnt(0)
    v_mfma_f32_32x32x16_bf16 v[64:79], v[48:51], v[44:47], v[64:79]
    v_mfma_f32_32x32x16_bf16 v[80:95], v[52:55], v[44:47], v[80:95]
    s_waitcnt vmcnt(12)
    s_barrier
    s_add_u32 m0, s32, 73728
    s_mov_b32 s40, 1408
    buffer_load_dwordx4 v10, s[8:11], s40 offen lds
    s_add_u32 m0, s32, 74752
    s_mov_b32 s40, 1408
    buffer_load_dwordx4 v11, s[8:11], s40 offen lds
    s_add_u32 m0, s33, 81920
    s_mov_b32 s40, 1441792
    buffer_load_dwordx4 v12, s[12:15], s40 offen lds
    s_add_u32 m0, s33, 82944
    s_mov_b32 s40, 1449984
    buffer_load_dwordx4 v12, s[12:15], s40 offen lds
    s_add_u32 m0, s33, 83968
    s_mov_b32 s40, 1458176
    buffer_load_dwordx4 v12, s[12:15], s40 offen lds
    s_add_u32 m0, s33, 84992
    s_mov_b32 s40, 1466368
    buffer_load_dwordx4 v12, s[12:15], s40 offen lds
    ds_read_b128 v[32:35], v16 offset:0
    ds_read_b64_tr_b16 v[36:37], v24 offset:0
    ds_read_b64_tr_b16 v[38:39], v24 offset:1024
    ds_read_b64_tr_b16 v[40:41], v25 offset:0
    ds_read_b64_tr_b16 v[42:43], v25 offset:1024
    ds_read_b128 v[44:47], v17 offset:0
    ds_read_b64_tr_b16 v[48:49], v24 offset:4096
    ds_read_b64_tr_b16 v[50:51], v24 offset:5120
    ds_read_b64_tr_b16 v[52:53], v25 offset:4096
    ds_read_b64_tr_b16 v[54:55], v25 offset:5120
    s_waitcnt lgkmcnt(5)
    v_mfma_f32_32x32x16_bf16 v[64:79], v[36:39], v[32:35], v[64:79]
    v_mfma_f32_32x32x16_bf16 v[80:95], v[40:43], v[32:35], v[80:95]
    ds_read_b128 v[32:35], v18 offset:0
    ds_read_b64_tr_b16 v[36:37], v24 offset:8192
    ds_read_b64_tr_b16 v[38:39], v24 offset:9216
    ds_read_b64_tr_b16 v[40:41], v25 offset:8192
    ds_read_b64_tr_b16 v[42:43], v25 offset:9216
    s_waitcnt lgkmcnt(5)
    v_mfma_f32_32x32x16_bf16 v[64:79], v[48:51], v[44:47], v[64:79]
    v_mfma_f32_32x32x16_bf16 v[80:95], v[52:55], v[44:47], v[80:95]
    ds_read_b128 v[44:47], v19 offset:0
    ds_read_b64_tr_b16 v[48:49], v24 offset:12288
    ds_read_b64_tr_b16 v[50:51], v24 offset:13312
    ds_read_b64_tr_b16 v[52:53], v25 offset:12288
    ds_read_b64_tr_b16 v[54:55], v25 offset:13312
    s_waitcnt lgkmcnt(5)
    v_mfma_f32_32x32x16_bf16 v[64:79], v[36:39], v[32:35], v[64:79]
    v_mfma_f32_32x32x16_bf16 v[80:95], v[40:43], v[32:35], v[80:95]
    s_waitcnt lgkmcnt(0)
    v_mfma_f32_32x32x16_bf16 v[64:79], v[48:51], v[44:47], v[64:79]
    v_mfma_f32_32x32x16_bf16 v[80:95], v[52:55], v[44:47], v[80:95]
    s_waitcnt vmcnt(12)
    s_barrier
    s_add_u32 m0, s32, 0
    s_mov_b32 s40, 1536
    buffer_load_dwordx4 v10, s[8:11], s40 offen lds
    s_add_u32 m0, s32, 1024
    s_mov_b32 s40, 1536
    buffer_load_dwordx4 v11, s[8:11], s40 offen lds
    s_add_u32 m0, s33, 8192
    s_mov_b32 s40, 1572864
    buffer_load_dwordx4 v12, s[12:15], s40 offen lds
    s_add_u32 m0, s33, 9216
    s_mov_b32 s40, 1581056
    buffer_load_dwordx4 v12, s[12:15], s40 offen lds
    s_add_u32 m0, s33, 10240
    s_mov_b32 s40, 1589248
    buffer_load_dwordx4 v12, s[12:15], s40 offen lds
    s_add_u32 m0, s33, 11264
    s_mov_b32 s40, 1597440
    buffer_load_dwordx4 v12, s[12:15], s40 offen lds
    ds_read_b128 v[32:35], v16 offset:24576
    ds_read_b64_tr_b16 v[36:37], v24 offset:24576
    ds_read_b64_tr_b16 v[38:39], v24 offset:25600
    ds_read_b64_tr_b16 v[40:41], v25 offset:24576
    ds_read_b64_tr_b16 v[42:43], v25 offset:25600
    ds_read_b128 v[44:47], v17 offset:24576
    ds_read_b64_tr_b16 v[48:49], v24 offset:28672
    ds_read_b64_tr_b16 v[50:51], v24 offset:29696
    ds_read_b64_tr_b16 v[52:53], v25 offset:28672
    ds_read_b64_tr_b16 v[54:55], v25 offset:29696
    s_waitcnt lgkmcnt(5)
    v_mfma_f32_32x32x16_bf16 v[64:79], v[36:39], v[32:35], v[64:79]
    v_mfma_f32_32x32x16_bf16 v[80:95], v[40:43], v[32:35], v[80:95]
    ds_read_b128 v[32:35], v18 offset:24576
    ds_read_b64_tr_b16 v[36:37], v24 offset:32768
    ds_read_b64_tr_b16 v[38:39], v24 offset:33792
    ds_read_b64_tr_b16 v[40:41], v25 offset:32768
    ds_read_b64_tr_b16 v[42:43], v25 offset:33792
    s_waitcnt lgkmcnt(5)
    v_mfma_f32_32x32x16_bf16 v[64:79], v[48:51], v[44:47], v[64:79]
    v_mfma_f32_32x32x16_bf16 v[80:95], v[52:55], v[44:47], v[80:95]
    ds_read_b128 v[44:47], v19 offset:24576
    ds_read_b64_tr_b16 v[48:49], v24 offset:36864
    ds_read_b64_tr_b16 v[50:51], v24 offset:37888
    ds_read_b64_tr_b16 v[52:53], v25 offset:36864
    ds_read_b64_tr_b16 v[54:55], v25 offset:37888
    s_waitcnt lgkmcnt(5)
    v_mfma_f32_32x32x16_bf16 v[64:79], v[36:39], v[32:35], v[64:79]
    v_mfma_f32_32x32x16_bf16 v[80:95], v[40:43], v[32:35], v[80:95]
    s_waitcnt lgkmcnt(0)
    v_mfma_f32_32x32x16_bf16 v[64:79], v[48:51], v[44:47], v[64:79]
    v_mfma_f32_32x32x16_bf16 v[80:95], v[52:55], v[44:47], v[80:95]
    s_waitcnt vmcnt(12)
    s_barrier
    s_add_u32 m0, s32, 24576
    s_mov_b32 s40, 1664
    buffer_load_dwordx4 v10, s[8:11], s40 offen lds
    s_add_u32 m0, s32, 25600
    s_mov_b32 s40, 1664
    buffer_load_dwordx4 v11, s[8:11], s40 offen lds
    s_add_u32 m0, s33, 32768
    s_mov_b32 s40, 1703936
    buffer_load_dwordx4 v12, s[12:15], s40 offen lds
    s_add_u32 m0, s33, 33792
    s_mov_b32 s40, 1712128
    buffer_load_dwordx4 v12, s[12:15], s40 offen lds
    s_add_u32 m0, s33, 34816
    s_mov_b32 s40, 1720320
    buffer_load_dwordx4 v12, s[12:15], s40 offen lds
    s_add_u32 m0, s33, 35840
    s_mov_b32 s40, 1728512
    buffer_load_dwordx4 v12, s[12:15], s40 offen lds
    ds_read_b128 v[32:35], v20 offset:0
    ds_read_b64_tr_b16 v[36:37], v26 offset:0
    ds_read_b64_tr_b16 v[38:39], v26 offset:1024
    ds_read_b64_tr_b16 v[40:41], v27 offset:0
    ds_read_b64_tr_b16 v[42:43], v27 offset:1024
    ds_read_b128 v[44:47], v21 offset:0
    ds_read_b64_tr_b16 v[48:49], v26 offset:4096
    ds_read_b64_tr_b16 v[50:51], v26 offset:5120
    ds_read_b64_tr_b16 v[52:53], v27 offset:4096
    ds_read_b64_tr_b16 v[54:55], v27 offset:5120
    s_waitcnt lgkmcnt(5)
    v_mfma_f32_32x32x16_bf16 v[64:79], v[36:39], v[32:35], v[64:79]
    v_mfma_f32_32x32x16_bf16 v[80:95], v[40:43], v[32:35], v[80:95]
    ds_read_b128 v[32:35], v22 offset:0
    ds_read_b64_tr_b16 v[36:37], v26 offset:8192
    ds_read_b64_tr_b16 v[38:39], v26 offset:9216
    ds_read_b64_tr_b16 v[40:41], v27 offset:8192
    ds_read_b64_tr_b16 v[42:43], v27 offset:9216
    s_waitcnt lgkmcnt(5)
    v_mfma_f32_32x32x16_bf16 v[64:79], v[48:51], v[44:47], v[64:79]
    v_mfma_f32_32x32x16_bf16 v[80:95], v[52:55], v[44:47], v[80:95]
    ds_read_b128 v[44:47], v23 offset:0
    ds_read_b64_tr_b16 v[48:49], v26 offset:12288
    ds_read_b64_tr_b16 v[50:51], v26 offset:13312
    ds_read_b64_tr_b16 v[52:53], v27 offset:12288
    ds_read_b64_tr_b16 v[54:55], v27 offset:13312
    s_waitcnt lgkmcnt(5)
    v_mfma_f32_32x32x16_bf16 v[64:79], v[36:39], v[32:35], v[64:79]
    v_mfma_f32_32x32x16_bf16 v[80:95], v[40:43], v[32:35], v[80:95]
    s_waitcnt lgkmcnt(0)
    v_mfma_f32_32x32x16_bf16 v[64:79], v[48:51], v[44:47], v[64:79]
    v_mfma_f32_32x32x16_bf16 v[80:95], v[52:55], v[44:47], v[80:95]
    s_waitcnt vmcnt(12)
    s_barrier
    s_add_u32 m0, s32, 49152
    s_mov_b32 s40, 1792
    buffer_load_dwordx4 v10, s[8:11], s40 offen lds
    s_add_u32 m0, s32, 50176
    s_mov_b32 s40, 1792
    buffer_load_dwordx4 v11, s[8:11], s40 offen lds
    s_add_u32 m0, s33, 57344
    s_mov_b32 s40, 1835008
    buffer_load_dwordx4 v12, s[12:15], s40 offen lds
    s_add_u32 m0, s33, 58368
    s_mov_b32 s40, 1843200
    buffer_load_dwordx4 v12, s[12:15], s40 offen lds
    s_add_u32 m0, s33, 59392
    s_mov_b32 s40, 1851392
    buffer_load_dwordx4 v12, s[12:15], s40 offen lds
    s_add_u32 m0, s33, 60416
    s_mov_b32 s40, 1859584
    buffer_load_dwordx4 v12, s[12:15], s40 offen lds
    ds_read_b128 v[32:35], v20 offset:24576
    ds_read_b64_tr_b16 v[36:37], v26 offset:24576
    ds_read_b64_tr_b16 v[38:39], v26 offset:25600
    ds_read_b64_tr_b16 v[40:41], v27 offset:24576
    ds_read_b64_tr_b16 v[42:43], v27 offset:25600
    ds_read_b128 v[44:47], v21 offset:24576
    ds_read_b64_tr_b16 v[48:49], v26 offset:28672
    ds_read_b64_tr_b16 v[50:51], v26 offset:29696
    ds_read_b64_tr_b16 v[52:53], v27 offset:28672
    ds_read_b64_tr_b16 v[54:55], v27 offset:29696
    s_waitcnt lgkmcnt(5)
    v_mfma_f32_32x32x16_bf16 v[64:79], v[36:39], v[32:35], v[64:79]
    v_mfma_f32_32x32x16_bf16 v[80:95], v[40:43], v[32:35], v[80:95]
    ds_read_b128 v[32:35], v22 offset:24576
    ds_read_b64_tr_b16 v[36:37], v26 offset:32768
    ds_read_b64_tr_b16 v[38:39], v26 offset:33792
    ds_read_b64_tr_b16 v[40:41], v27 offset:32768
    ds_read_b64_tr_b16 v[42:43], v27 offset:33792
    s_waitcnt lgkmcnt(5)
    v_mfma_f32_32x32x16_bf16 v[64:79], v[48:51], v[44:47], v[64:79]
    v_mfma_f32_32x32x16_bf16 v[80:95], v[52:55], v[44:47], v[80:95]
    ds_read_b128 v[44:47], v23 offset:24576
    ds_read_b64_tr_b16 v[48:49], v26 offset:36864
    ds_read_b64_tr_b16 v[50:51], v26 offset:37888
    ds_read_b64_tr_b16 v[52:53], v27 offset:36864
    ds_read_b64_tr_b16 v[54:55], v27 offset:37888
    s_waitcnt lgkmcnt(5)
    v_mfma_f32_32x32x16_bf16 v[64:79], v[36:39], v[32:35], v[64:79]
    v_mfma_f32_32x32x16_bf16 v[80:95], v[40:43], v[32:35], v[80:95]
    s_waitcnt lgkmcnt(0)
    v_mfma_f32_32x32x16_bf16 v[64:79], v[48:51], v[44:47], v[64:79]
    v_mfma_f32_32x32x16_bf16 v[80:95], v[52:55], v[44:47], v[80:95]
    s_waitcnt vmcnt(12)
    s_barrier
    s_add_u32 m0, s32, 73728
    s_mov_b32 s40, 1920
    buffer_load_dwordx4 v10, s[8:11], s40 offen lds
    s_add_u32 m0, s32, 74752
    s_mov_b32 s40, 1920
    buffer_load_dwordx4 v11, s[8:11], s40 offen lds
    s_add_u32 m0, s33, 81920
    s_mov_b32 s40, 1966080
    buffer_load_dwordx4 v12, s[12:15], s40 offen lds
    s_add_u32 m0, s33, 82944
    s_mov_b32 s40, 1974272
    buffer_load_dwordx4 v12, s[12:15], s40 offen lds
    s_add_u32 m0, s33, 83968
    s_mov_b32 s40, 1982464
    buffer_load_dwordx4 v12, s[12:15], s40 offen lds
    s_add_u32 m0, s33, 84992
    s_mov_b32 s40, 1990656
    buffer_load_dwordx4 v12, s[12:15], s40 offen lds
    ds_read_b128 v[32:35], v16 offset:0
    ds_read_b64_tr_b16 v[36:37], v24 offset:0
    ds_read_b64_tr_b16 v[38:39], v24 offset:1024
    ds_read_b64_tr_b16 v[40:41], v25 offset:0
    ds_read_b64_tr_b16 v[42:43], v25 offset:1024
    ds_read_b128 v[44:47], v17 offset:0
    ds_read_b64_tr_b16 v[48:49], v24 offset:4096
    ds_read_b64_tr_b16 v[50:51], v24 offset:5120
    ds_read_b64_tr_b16 v[52:53], v25 offset:4096
    ds_read_b64_tr_b16 v[54:55], v25 offset:5120
    s_waitcnt lgkmcnt(5)
    v_mfma_f32_32x32x16_bf16 v[64:79], v[36:39], v[32:35], v[64:79]
    v_mfma_f32_32x32x16_bf16 v[80:95], v[40:43], v[32:35], v[80:95]
    ds_read_b128 v[32:35], v18 offset:0
    ds_read_b64_tr_b16 v[36:37], v24 offset:8192
    ds_read_b64_tr_b16 v[38:39], v24 offset:9216
    ds_read_b64_tr_b16 v[40:41], v25 offset:8192
    ds_read_b64_tr_b16 v[42:43], v25 offset:9216
    s_waitcnt lgkmcnt(5)
    v_mfma_f32_32x32x16_bf16 v[64:79], v[48:51], v[44:47], v[64:79]
    v_mfma_f32_32x32x16_bf16 v[80:95], v[52:55], v[44:47], v[80:95]
    ds_read_b128 v[44:47], v19 offset:0
    ds_read_b64_tr_b16 v[48:49], v24 offset:12288
    ds_read_b64_tr_b16 v[50:51], v24 offset:13312
    ds_read_b64_tr_b16 v[52:53], v25 offset:12288
    ds_read_b64_tr_b16 v[54:55], v25 offset:13312
    s_waitcnt lgkmcnt(5)
    v_mfma_f32_32x32x16_bf16 v[64:79], v[36:39], v[32:35], v[64:79]
    v_mfma_f32_32x32x16_bf16 v[80:95], v[40:43], v[32:35], v[80:95]
    s_waitcnt lgkmcnt(0)
    v_mfma_f32_32x32x16_bf16 v[64:79], v[48:51], v[44:47], v[64:79]
    v_mfma_f32_32x32x16_bf16 v[80:95], v[52:55], v[44:47], v[80:95]
    s_waitcnt vmcnt(12)
    s_barrier
    ds_read_b128 v[32:35], v16 offset:24576
    ds_read_b64_tr_b16 v[36:37], v24 offset:24576
    ds_read_b64_tr_b16 v[38:39], v24 offset:25600
    ds_read_b64_tr_b16 v[40:41], v25 offset:24576
    ds_read_b64_tr_b16 v[42:43], v25 offset:25600
    ds_read_b128 v[44:47], v17 offset:24576
    ds_read_b64_tr_b16 v[48:49], v24 offset:28672
    ds_read_b64_tr_b16 v[50:51], v24 offset:29696
    ds_read_b64_tr_b16 v[52:53], v25 offset:28672
    ds_read_b64_tr_b16 v[54:55], v25 offset:29696
    s_waitcnt lgkmcnt(5)
    v_mfma_f32_32x32x16_bf16 v[64:79], v[36:39], v[32:35], v[64:79]
    v_mfma_f32_32x32x16_bf16 v[80:95], v[40:43], v[32:35], v[80:95]
    ds_read_b128 v[32:35], v18 offset:24576
    ds_read_b64_tr_b16 v[36:37], v24 offset:32768
    ds_read_b64_tr_b16 v[38:39], v24 offset:33792
    ds_read_b64_tr_b16 v[40:41], v25 offset:32768
    ds_read_b64_tr_b16 v[42:43], v25 offset:33792
    s_waitcnt lgkmcnt(5)
    v_mfma_f32_32x32x16_bf16 v[64:79], v[48:51], v[44:47], v[64:79]
    v_mfma_f32_32x32x16_bf16 v[80:95], v[52:55], v[44:47], v[80:95]
    ds_read_b128 v[44:47], v19 offset:24576
    ds_read_b64_tr_b16 v[48:49], v24 offset:36864
    ds_read_b64_tr_b16 v[50:51], v24 offset:37888
    ds_read_b64_tr_b16 v[52:53], v25 offset:36864
    ds_read_b64_tr_b16 v[54:55], v25 offset:37888
    s_waitcnt lgkmcnt(5)
    v_mfma_f32_32x32x16_bf16 v[64:79], v[36:39], v[32:35], v[64:79]
    v_mfma_f32_32x32x16_bf16 v[80:95], v[40:43], v[32:35], v[80:95]
    s_waitcnt lgkmcnt(0)
    v_mfma_f32_32x32x16_bf16 v[64:79], v[48:51], v[44:47], v[64:79]
    v_mfma_f32_32x32x16_bf16 v[80:95], v[52:55], v[44:47], v[80:95]
    s_waitcnt vmcnt(6)
    s_barrier
    ds_read_b128 v[32:35], v20 offset:0
    ds_read_b64_tr_b16 v[36:37], v26 offset:0
    ds_read_b64_tr_b16 v[38:39], v26 offset:1024
    ds_read_b64_tr_b16 v[40:41], v27 offset:0
    ds_read_b64_tr_b16 v[42:43], v27 offset:1024
    ds_read_b128 v[44:47], v21 offset:0
    ds_read_b64_tr_b16 v[48:49], v26 offset:4096
    ds_read_b64_tr_b16 v[50:51], v26 offset:5120
    ds_read_b64_tr_b16 v[52:53], v27 offset:4096
    ds_read_b64_tr_b16 v[54:55], v27 offset:5120
    s_waitcnt lgkmcnt(5)
    v_mfma_f32_32x32x16_bf16 v[64:79], v[36:39], v[32:35], v[64:79]
    v_mfma_f32_32x32x16_bf16 v[80:95], v[40:43], v[32:35], v[80:95]
    ds_read_b128 v[32:35], v22 offset:0
    ds_read_b64_tr_b16 v[36:37], v26 offset:8192
    ds_read_b64_tr_b16 v[38:39], v26 offset:9216
    ds_read_b64_tr_b16 v[40:41], v27 offset:8192
    ds_read_b64_tr_b16 v[42:43], v27 offset:9216
    s_waitcnt lgkmcnt(5)
    v_mfma_f32_32x32x16_bf16 v[64:79], v[48:51], v[44:47], v[64:79]
    v_mfma_f32_32x32x16_bf16 v[80:95], v[52:55], v[44:47], v[80:95]
    ds_read_b128 v[44:47], v23 offset:0
    ds_read_b64_tr_b16 v[48:49], v26 offset:12288
    ds_read_b64_tr_b16 v[50:51], v26 offset:13312
    ds_read_b64_tr_b16 v[52:53], v27 offset:12288
    ds_read_b64_tr_b16 v[54:55], v27 offset:13312
    s_waitcnt lgkmcnt(5)
    v_mfma_f32_32x32x16_bf16 v[64:79], v[36:39], v[32:35], v[64:79]
    v_mfma_f32_32x32x16_bf16 v[80:95], v[40:43], v[32:35], v[80:95]
    s_waitcnt lgkmcnt(0)
    v_mfma_f32_32x32x16_bf16 v[64:79], v[48:51], v[44:47], v[64:79]
    v_mfma_f32_32x32x16_bf16 v[80:95], v[52:55], v[44:47], v[80:95]
    s_waitcnt vmcnt(0)
    s_barrier
    ds_read_b128 v[32:35], v20 offset:24576
    ds_read_b64_tr_b16 v[36:37], v26 offset:24576
    ds_read_b64_tr_b16 v[38:39], v26 offset:25600
    ds_read_b64_tr_b16 v[40:41], v27 offset:24576
    ds_read_b64_tr_b16 v[42:43], v27 offset:25600
    ds_read_b128 v[44:47], v21 offset:24576
    ds_read_b64_tr_b16 v[48:49], v26 offset:28672
    ds_read_b64_tr_b16 v[50:51], v26 offset:29696
    ds_read_b64_tr_b16 v[52:53], v27 offset:28672
    ds_read_b64_tr_b16 v[54:55], v27 offset:29696
    s_waitcnt lgkmcnt(5)
    v_mfma_f32_32x32x16_bf16 v[64:79], v[36:39], v[32:35], v[64:79]
    v_mfma_f32_32x32x16_bf16 v[80:95], v[40:43], v[32:35], v[80:95]
    ds_read_b128 v[32:35], v22 offset:24576
    ds_read_b64_tr_b16 v[36:37], v26 offset:32768
    ds_read_b64_tr_b16 v[38:39], v26 offset:33792
    ds_read_b64_tr_b16 v[40:41], v27 offset:32768
    ds_read_b64_tr_b16 v[42:43], v27 offset:33792
    s_waitcnt lgkmcnt(5)
    v_mfma_f32_32x32x16_bf16 v[64:79], v[48:51], v[44:47], v[64:79]
    v_mfma_f32_32x32x16_bf16 v[80:95], v[52:55], v[44:47], v[80:95]
    ds_read_b128 v[44:47], v23 offset:24576
    ds_read_b64_tr_b16 v[48:49], v26 offset:36864
    ds_read_b64_tr_b16 v[50:51], v26 offset:37888
    ds_read_b64_tr_b16 v[52:53], v27 offset:36864
    ds_read_b64_tr_b16 v[54:55], v27 offset:37888
    s_waitcnt lgkmcnt(5)
    v_mfma_f32_32x32x16_bf16 v[64:79], v[36:39], v[32:35], v[64:79]
    v_mfma_f32_32x32x16_bf16 v[80:95], v[40:43], v[32:35], v[80:95]
    s_waitcnt lgkmcnt(0)
    v_mfma_f32_32x32x16_bf16 v[64:79], v[48:51], v[44:47], v[64:79]
    v_mfma_f32_32x32x16_bf16 v[80:95], v[52:55], v[44:47], v[80:95]
    v_and_b32 v2, 31, v1
    v_lshrrev_b32 v3, 5, v1
    s_lshl_b32 s38, s4, 6
    s_lshl_b32 s39, s36, 5
    s_add_u32 s38, s38, s39
    v_add_u32 v2, s38, v2
    v_lshlrev_b32 v2, 12, v2
    v_lshl_add_u32 v2, v3, 4, v2
    s_lshl_b32 s38, s5, 21
    s_lshl_b32 s39, s3, 9
    s_add_u32 s38, s38, s39
    s_lshl_b32 s39, s37, 8
    s_add_u32 s38, s38, s39
    v_add_u32 v2, s38, v2
    s_nop 7
    s_nop 3
    buffer_store_dwordx4 v[64:67], v2, s[24:27], 0 offen offset:0
    buffer_store_dwordx4 v[68:71], v2, s[24:27], 0 offen offset:32
    buffer_store_dwordx4 v[72:75], v2, s[24:27], 0 offen offset:64
    buffer_store_dwordx4 v[76:79], v2, s[24:27], 0 offen offset:96
    buffer_store_dwordx4 v[80:83], v2, s[24:27], 0 offen offset:128
    buffer_store_dwordx4 v[84:87], v2, s[24:27], 0 offen offset:160
    buffer_store_dwordx4 v[88:91], v2, s[24:27], 0 offen offset:192
    buffer_store_dwordx4 v[92:95], v2, s[24:27], 0 offen offset:224
L2_done:
    s_endpgm
.globl mha_reduce_kernel
.p2align 8
.type mha_reduce_kernel,@function
mha_reduce_kernel:
    s_cmp_ge_u32 s2, 256
    s_cbranch_scc1 L3_done
    s_load_dwordx2 s[44:45], s[0:1], 40
    s_load_dwordx2 s[52:53], s[0:1], 56
    s_lshl_b32 s3, s2, 8
    v_add_u32 v1, s3, v0
    s_waitcnt lgkmcnt(0)
    s_add_u32 s52, s52, 0x400000
    s_addc_u32 s53, s53, 0
    s_mov_b32 s8, s52
    s_mov_b32 s9, s53
    s_mov_b32 s10, 8388608
    s_mov_b32 s11, 0x00020000
    s_mov_b32 s12, s44
    s_mov_b32 s13, s45
    s_mov_b32 s14, 1048576
    s_mov_b32 s15, 0x00020000
    v_lshlrev_b32 v2, 5, v1
    v_lshlrev_b32 v3, 4, v1
    s_mov_b32 s4, 0
    buffer_load_dwordx4 v[8:11], v2, s[8:11], s4 offen
    buffer_load_dwordx4 v[12:15], v2, s[8:11], s4 offen offset:16
    s_mov_b32 s4, 2097152
    buffer_load_dwordx4 v[16:19], v2, s[8:11], s4 offen
    buffer_load_dwordx4 v[20:23], v2, s[8:11], s4 offen offset:16
    s_mov_b32 s4, 4194304
    buffer_load_dwordx4 v[24:27], v2, s[8:11], s4 offen
    buffer_load_dwordx4 v[28:31], v2, s[8:11], s4 offen offset:16
    s_mov_b32 s4, 6291456
    buffer_load_dwordx4 v[32:35], v2, s[8:11], s4 offen
    buffer_load_dwordx4 v[36:39], v2, s[8:11], s4 offen offset:16
    s_waitcnt vmcnt(0)
    v_add_f32 v8, v8, v16
    v_add_f32 v24, v24, v32
    v_add_f32 v8, v8, v24
    v_add_f32 v9, v9, v17
    v_add_f32 v25, v25, v33
    v_add_f32 v9, v9, v25
    v_add_f32 v10, v10, v18
    v_add_f32 v26, v26, v34
    v_add_f32 v10, v10, v26
    v_add_f32 v11, v11, v19
    v_add_f32 v27, v27, v35
    v_add_f32 v11, v11, v27
    v_add_f32 v12, v12, v20
    v_add_f32 v28, v28, v36
    v_add_f32 v12, v12, v28
    v_add_f32 v13, v13, v21
    v_add_f32 v29, v29, v37
    v_add_f32 v13, v13, v29
    v_add_f32 v14, v14, v22
    v_add_f32 v30, v30, v38
    v_add_f32 v14, v14, v30
    v_add_f32 v15, v15, v23
    v_add_f32 v31, v31, v39
    v_add_f32 v15, v15, v31
    v_cvt_pk_bf16_f32 v40, v8, v9
    v_cvt_pk_bf16_f32 v41, v10, v11
    v_cvt_pk_bf16_f32 v42, v12, v13
    v_cvt_pk_bf16_f32 v43, v14, v15
    buffer_store_dwordx4 v[40:43], v3, s[12:15], 0 offen
L3_done:
    s_endpgm
.section .rodata,"a"
.p2align 6
.amdhsa_kernel mha_qattn_kernel
  .amdhsa_next_free_vgpr 128
  .amdhsa_next_free_sgpr 64
  .amdhsa_accum_offset 128
  .amdhsa_group_segment_fixed_size 0
  .amdhsa_kernarg_size 64
  .amdhsa_user_sgpr_count 2
  .amdhsa_user_sgpr_kernarg_segment_ptr 1
  .amdhsa_system_sgpr_workgroup_id_x 1
.end_amdhsa_kernel
.p2align 6
.amdhsa_kernel mha_oproj_kernel
  .amdhsa_next_free_vgpr 128
  .amdhsa_next_free_sgpr 64
  .amdhsa_accum_offset 128
  .amdhsa_group_segment_fixed_size 0
  .amdhsa_kernarg_size 64
  .amdhsa_user_sgpr_count 2
  .amdhsa_user_sgpr_kernarg_segment_ptr 1
  .amdhsa_system_sgpr_workgroup_id_x 1
.end_amdhsa_kernel
.p2align 6
.amdhsa_kernel mha_reduce_kernel
  .amdhsa_next_free_vgpr 64
  .amdhsa_next_free_sgpr 64
  .amdhsa_accum_offset 64
  .amdhsa_group_segment_fixed_size 0
  .amdhsa_kernarg_size 64
  .amdhsa_user_sgpr_count 2
  .amdhsa_user_sgpr_kernarg_segment_ptr 1
  .amdhsa_system_sgpr_workgroup_id_x 1
.end_amdhsa_kernel
```
